```python
import torch

def _softmax(x, axis=-1):
    return torch.softmax(x, dim=axis)
def _gelu(x):
    return torch.nn.functional.gelu(x, approximate="tanh")
def _silu(x):
    return torch.nn.functional.silu(x)
def _sigmoid(x):
    return torch.sigmoid(x)
def _layernorm(x, axis=-1, eps=1e-5):
    m = x.mean(dim=axis, keepdim=True)
    v = x.var(dim=axis, keepdim=True, unbiased=False)
    return (x - m) / torch.sqrt(v + eps)
def _scatter_add(tgt, idx, src, axis=0):
    return tgt.clone().index_add_(axis, idx, src)
def _segment_sum(src, seg, n):
    out = torch.zeros((n,) + src.shape[1:], dtype=src.dtype)
    return out.index_add_(0, seg, src)
def _pad(x, pw):
    flat = tuple(v for pair in reversed(pw) for v in pair)
    return torch.nn.functional.pad(x, flat)

kernel_name = 'standalone__gqa_softmax__near_ridge'

def setup_inputs():

    _w = (lambda a: (lambda t: t.to(torch.bfloat16) if t.is_floating_point() else t)(torch.as_tensor(a)))
    B, Hq, Hkv, Sq, Sk, D = 8, 32, 16, 96, 2048, 128
    return {
        "q": _w((lambda *s: torch.randn(*s, dtype=torch.bfloat16) * 0.8)(B, Hq, Sq, D)),
        "k": _w((lambda *s: torch.randn(*s, dtype=torch.bfloat16) * 0.8)(B, Hkv, Sk, D)),
        "v": _w((lambda *s: torch.randn(*s, dtype=torch.bfloat16) * 0.05)(B, Hkv, Sk, D)),
    }

def reference(q, k, v):
    B, Hq, Sq, D = q.shape
    Hkv = k.shape[1]
    rep = Hq // Hkv
    k = (lambda x, n, axis: torch.repeat_interleave(x, n, dim=axis))(k, rep, axis=1)
    v = (lambda x, n, axis: torch.repeat_interleave(x, n, dim=axis))(v, rep, axis=1)
    scale = D ** -0.5
    scores = torch.einsum("bhqd,bhkd->bhqk", q, k) * scale
    p = _softmax(scores, axis=-1)
    return torch.einsum("bhqk,bhkd->bhqd", p, v)
```

```asm
; @launch grid=(256,1,1) block=(256,1,1) lds=163840
.amdgcn_target "amdgcn-amd-amdhsa--gfx950"
.text
.globl standalone__gqa_softmax__near_ridge_kernel
.p2align 8
.type standalone__gqa_softmax__near_ridge_kernel,@function
standalone__gqa_softmax__near_ridge_kernel:
    s_cmp_ge_u32 s2, 256
    s_cbranch_scc1 L_END
    s_load_dwordx4 s[4:7], s[0:1], 0
    s_load_dwordx4 s[8:11], s[0:1], 16
    s_lshr_b32 s28, s2, 4
    s_lshl_b32 s28, s28, 3
    s_and_b32 s29, s2, 7
    s_add_u32 s28, s28, s29
    s_lshr_b32 s29, s2, 3
    s_and_b32 s29, s29, 1
    v_lshrrev_b32 v1, 6, v0
    s_nop 0
    v_readfirstlane_b32 s30, v1
    v_and_b32 v1, 63, v0
    s_mul_i32 s31, s30, 40960
    s_mov_b32 s32, s31
    s_add_u32 s40, s31, 32768
    s_mov_b32 s37, 0x3e0293ee
    s_mov_b32 s39, 0x41000000
    s_lshl_b32 s52, s28, 19
    s_lshl_b32 s33, s30, 13
    s_mov_b32 s34, s33
    s_lshl_b32 s41, s28, 1
    s_add_u32 s41, s41, s29
    s_mul_i32 s41, s41, 24576
    s_add_u32 s42, s41, 8192
    s_add_u32 s43, s41, 16384
    v_lshrrev_b32 v184, 4, v1
    v_and_b32 v185, 15, v1
    v_add_u32 v186, 0, v184
    v_xor_b32 v186, v186, v185
    v_lshlrev_b32 v186, 4, v186
    v_lshl_add_u32 v2, v184, 8, v186
    v_add_u32 v186, 4, v184
    v_xor_b32 v186, v186, v185
    v_lshlrev_b32 v186, 4, v186
    v_lshl_add_u32 v3, v184, 8, v186
    v_add_u32 v186, 8, v184
    v_xor_b32 v186, v186, v185
    v_lshlrev_b32 v186, 4, v186
    v_lshl_add_u32 v4, v184, 8, v186
    v_add_u32 v186, 12, v184
    v_xor_b32 v186, v186, v185
    v_lshlrev_b32 v186, 4, v186
    v_lshl_add_u32 v5, v184, 8, v186
    v_lshlrev_b32 v186, 2, v184
    v_xor_b32 v186, v186, v185
    v_lshlrev_b32 v186, 4, v186
    v_lshl_add_u32 v6, v184, 8, v186
    v_and_b32 v186, 31, v1
    v_lshrrev_b32 v187, 5, v1
    v_xor_b32 v188, v187, v185
    v_lshlrev_b32 v188, 4, v188
    v_lshl_add_u32 v7, v186, 8, v188
    v_lshrrev_b32 v188, 2, v185
    v_lshl_add_u32 v189, v187, 2, v188
    v_lshlrev_b32 v189, 8, v189
    v_lshl_add_u32 v189, v188, 6, v189
    v_and_b32 v188, 1, v184
    v_lshl_add_u32 v189, v188, 5, v189
    v_and_b32 v188, 3, v1
    v_lshl_add_u32 v189, v188, 3, v189
    v_mov_b32 v8, v189
    v_mov_b32 v204, v186
    v_mov_b32 v205, v187
    v_mov_b32 v13, 0
    v_mov_b32 v10, 0xff800000
    v_mov_b32 v14, 0
    v_mov_b32 v11, 0xff800000
    v_mov_b32 v15, 0
    v_mov_b32 v12, 0xff800000
    s_mov_b32 s53, 0x7fff0000
    s_mov_b32 s38, 0
    s_waitcnt lgkmcnt(0)
    s_mov_b32 s12, s4
    s_and_b32 s13, s5, 0xffff
    s_mov_b32 s14, 6291456
    s_mov_b32 s15, 0x00020000
    s_mov_b32 s16, s6
    s_and_b32 s17, s7, 0xffff
    s_mov_b32 s18, 67108864
    s_mov_b32 s19, 0x00020000
    s_mov_b32 s20, s8
    s_and_b32 s21, s9, 0xffff
    s_mov_b32 s22, 67108864
    s_mov_b32 s23, 0x00020000
    s_mov_b32 s24, s10
    s_and_b32 s25, s11, 0xffff
    s_mov_b32 s26, 6291456
    s_mov_b32 s27, 0x00020000
    s_add_u32 m0, s31, 0
    s_add_u32 s47, s33, s52
    s_add_u32 s35, s47, 4096
    buffer_load_dwordx4 v2, s[16:19], s47 offen offset:0 nt lds
    buffer_load_dwordx4 v3, s[16:19], s47 offen offset:1024 nt lds
    buffer_load_dwordx4 v4, s[16:19], s47 offen offset:2048 nt lds
    buffer_load_dwordx4 v5, s[16:19], s47 offen offset:3072 nt lds
    s_add_u32 m0, s31, 4096
    s_nop 0
    buffer_load_dwordx4 v2, s[16:19], s35 offen offset:0 nt lds
    buffer_load_dwordx4 v3, s[16:19], s35 offen offset:1024 nt lds
    buffer_load_dwordx4 v4, s[16:19], s35 offen offset:2048 nt lds
    buffer_load_dwordx4 v5, s[16:19], s35 offen offset:3072 nt lds
    s_add_u32 s33, s33, 32768
    s_mul_i32 s54, s30, 24
    s_add_u32 s55, s31, 32768
    s_mul_i32 s56, s30, 6144
    s_add_u32 s56, s56, s41
    s_add_u32 s57, s54, 0
    v_add_u32 v186, s57, v184
    v_xor_b32 v186, v186, v185
    v_and_b32 v186, 15, v186
    v_lshlrev_b32 v186, 4, v186
    v_lshl_add_u32 v190, v184, 8, v186
    s_add_u32 s57, s54, 4
    v_add_u32 v186, s57, v184
    v_xor_b32 v186, v186, v185
    v_and_b32 v186, 15, v186
    v_lshlrev_b32 v186, 4, v186
    v_lshl_add_u32 v191, v184, 8, v186
    s_add_u32 s57, s54, 8
    v_add_u32 v186, s57, v184
    v_xor_b32 v186, v186, v185
    v_and_b32 v186, 15, v186
    v_lshlrev_b32 v186, 4, v186
    v_lshl_add_u32 v192, v184, 8, v186
    s_add_u32 s57, s54, 12
    v_add_u32 v186, s57, v184
    v_xor_b32 v186, v186, v185
    v_and_b32 v186, 15, v186
    v_lshlrev_b32 v186, 4, v186
    v_lshl_add_u32 v193, v184, 8, v186
    s_add_u32 s57, s54, 16
    v_add_u32 v186, s57, v184
    v_xor_b32 v186, v186, v185
    v_and_b32 v186, 15, v186
    v_lshlrev_b32 v186, 4, v186
    v_lshl_add_u32 v194, v184, 8, v186
    s_add_u32 s57, s54, 20
    v_add_u32 v186, s57, v184
    v_xor_b32 v186, v186, v185
    v_and_b32 v186, 15, v186
    v_lshlrev_b32 v186, 4, v186
    v_lshl_add_u32 v195, v184, 8, v186
    s_add_u32 s57, s55, 0
    s_mov_b32 m0, s57
    s_add_u32 s58, s56, 0
    buffer_load_dwordx4 v190, s[12:15], s58 offen offset:0 lds
    buffer_load_dwordx4 v191, s[12:15], s58 offen offset:1024 lds
    buffer_load_dwordx4 v192, s[12:15], s58 offen offset:2048 lds
    buffer_load_dwordx4 v193, s[12:15], s58 offen offset:3072 lds
    s_add_u32 s57, s55, 4096
    s_mov_b32 m0, s57
    s_add_u32 s58, s56, 4096
    buffer_load_dwordx4 v194, s[12:15], s58 offen offset:0 lds
    buffer_load_dwordx4 v195, s[12:15], s58 offen offset:1024 lds
    s_add_u32 m0, s31, 16384
    s_add_u32 s47, s34, s52
    s_add_u32 s35, s47, 4096
    buffer_load_dwordx4 v6, s[20:23], s47 offen offset:0 nt lds
    buffer_load_dwordx4 v6, s[20:23], s47 offen offset:1024 nt lds
    buffer_load_dwordx4 v6, s[20:23], s47 offen offset:2048 nt lds
    buffer_load_dwordx4 v6, s[20:23], s47 offen offset:3072 nt lds
    s_add_u32 m0, s31, 20480
    s_nop 0
    buffer_load_dwordx4 v6, s[20:23], s35 offen offset:0 nt lds
    buffer_load_dwordx4 v6, s[20:23], s35 offen offset:1024 nt lds
    buffer_load_dwordx4 v6, s[20:23], s35 offen offset:2048 nt lds
    buffer_load_dwordx4 v6, s[20:23], s35 offen offset:3072 nt lds
    s_add_u32 s34, s34, 32768
    s_add_u32 m0, s31, 8192
    s_add_u32 s47, s33, s52
    s_add_u32 s35, s47, 4096
    buffer_load_dwordx4 v2, s[16:19], s47 offen offset:0 nt lds
    buffer_load_dwordx4 v3, s[16:19], s47 offen offset:1024 nt lds
    buffer_load_dwordx4 v4, s[16:19], s47 offen offset:2048 nt lds
    buffer_load_dwordx4 v5, s[16:19], s47 offen offset:3072 nt lds
    s_add_u32 m0, s31, 12288
    s_nop 0
    buffer_load_dwordx4 v2, s[16:19], s35 offen offset:0 nt lds
    buffer_load_dwordx4 v3, s[16:19], s35 offen offset:1024 nt lds
    buffer_load_dwordx4 v4, s[16:19], s35 offen offset:2048 nt lds
    buffer_load_dwordx4 v5, s[16:19], s35 offen offset:3072 nt lds
    s_add_u32 s33, s33, 32768
    s_add_u32 m0, s31, 24576
    s_add_u32 s47, s34, s52
    s_add_u32 s35, s47, 4096
    buffer_load_dwordx4 v6, s[20:23], s47 offen offset:0 nt lds
    buffer_load_dwordx4 v6, s[20:23], s47 offen offset:1024 nt lds
    buffer_load_dwordx4 v6, s[20:23], s47 offen offset:2048 nt lds
    buffer_load_dwordx4 v6, s[20:23], s47 offen offset:3072 nt lds
    s_add_u32 m0, s31, 28672
    s_nop 0
    buffer_load_dwordx4 v6, s[20:23], s35 offen offset:0 nt lds
    buffer_load_dwordx4 v6, s[20:23], s35 offen offset:1024 nt lds
    buffer_load_dwordx4 v6, s[20:23], s35 offen offset:2048 nt lds
    buffer_load_dwordx4 v6, s[20:23], s35 offen offset:3072 nt lds
    s_add_u32 s34, s34, 32768
    v_add_u32 v184, s31, v7
    v_xor_b32 v185, 32, v184
    v_xor_b32 v186, 64, v184
    v_xor_b32 v187, 96, v184
    v_xor_b32 v188, 128, v184
    v_xor_b32 v189, 160, v184
    v_xor_b32 v190, 192, v184
    v_xor_b32 v191, 224, v184
    v_add_u32 v192, s31, v8
    v_xor_b32 v193, 64, v192
    v_xor_b32 v194, 128, v192
    v_xor_b32 v195, 192, v192
    v_add_u32 v196, 0, v204
    v_mul_u32_u24 v197, 43, v196
    v_lshrrev_b32 v197, 10, v197
    v_mul_u32_u24 v198, 24, v197
    v_sub_u32 v198, v196, v198
    v_mul_u32_u24 v197, 40960, v197
    v_lshl_add_u32 v197, v198, 8, v197
    v_and_b32 v198, 15, v196
    v_xor_b32 v198, v198, v205
    v_lshl_add_u32 v197, v198, 4, v197
    v_add_u32 v200, 32768, v197
    v_add_u32 v196, 32, v204
    v_mul_u32_u24 v197, 43, v196
    v_lshrrev_b32 v197, 10, v197
    v_mul_u32_u24 v198, 24, v197
    v_sub_u32 v198, v196, v198
    v_mul_u32_u24 v197, 40960, v197
    v_lshl_add_u32 v197, v198, 8, v197
    v_and_b32 v198, 15, v196
    v_xor_b32 v198, v198, v205
    v_lshl_add_u32 v197, v198, 4, v197
    v_add_u32 v201, 32768, v197
    v_add_u32 v196, 64, v204
    v_mul_u32_u24 v197, 43, v196
    v_lshrrev_b32 v197, 10, v197
    v_mul_u32_u24 v198, 24, v197
    v_sub_u32 v198, v196, v198
    v_mul_u32_u24 v197, 40960, v197
    v_lshl_add_u32 v197, v198, 8, v197
    v_and_b32 v198, 15, v196
    v_xor_b32 v198, v198, v205
    v_lshl_add_u32 v197, v198, 4, v197
    v_add_u32 v202, 32768, v197
    v_mov_b32 v112, 0
    v_mov_b32 v113, 0
    v_mov_b32 v114, 0
    v_mov_b32 v115, 0
    v_mov_b32 v144, 0xff800000
    v_mov_b32 v145, 0xff800000
    v_mov_b32 v146, 0xff800000
    v_mov_b32 v147, 0xff800000
    v_mov_b32 v148, 0xff800000
    v_mov_b32 v149, 0xff800000
    v_mov_b32 v150, 0xff800000
    v_mov_b32 v151, 0xff800000
    v_mov_b32 v152, 0xff800000
    v_mov_b32 v153, 0xff800000
    v_mov_b32 v154, 0xff800000
    v_mov_b32 v155, 0xff800000
    v_mov_b32 v156, 0xff800000
    v_mov_b32 v157, 0xff800000
    v_mov_b32 v158, 0xff800000
    v_mov_b32 v159, 0xff800000
    s_nop 1
    v_mfma_f32_32x32x16_bf16 a[0:15], v[112:115], v[112:115], 0
    v_mfma_f32_32x32x16_bf16 a[16:31], v[112:115], v[112:115], 0
    v_mfma_f32_32x32x16_bf16 a[32:47], v[112:115], v[112:115], 0
    v_mfma_f32_32x32x16_bf16 a[48:63], v[112:115], v[112:115], 0
    v_mfma_f32_32x32x16_bf16 a[64:79], v[112:115], v[112:115], 0
    v_mfma_f32_32x32x16_bf16 a[80:95], v[112:115], v[112:115], 0
    v_mfma_f32_32x32x16_bf16 a[96:111], v[112:115], v[112:115], 0
    v_mfma_f32_32x32x16_bf16 a[112:127], v[112:115], v[112:115], 0
    v_mfma_f32_32x32x16_bf16 a[128:143], v[112:115], v[112:115], 0
    v_mfma_f32_32x32x16_bf16 a[144:159], v[112:115], v[112:115], 0
    v_mfma_f32_32x32x16_bf16 a[160:175], v[112:115], v[112:115], 0
    v_mfma_f32_32x32x16_bf16 a[176:191], v[112:115], v[112:115], 0
    v_mfma_f32_32x32x16_bf16 a[224:239], v[112:115], v[112:115], 0
    v_mfma_f32_32x32x16_bf16 a[240:255], v[112:115], v[112:115], 0
    s_waitcnt vmcnt(24)
    s_barrier
    ds_read_b128 v[16:19], v200
    v_xor_b32 v207, 32, v200
    ds_read_b128 v[20:23], v207
    v_xor_b32 v208, 64, v200
    ds_read_b128 v[24:27], v208
    v_xor_b32 v209, 96, v200
    ds_read_b128 v[28:31], v209
    v_xor_b32 v206, 128, v200
    ds_read_b128 v[32:35], v206
    v_xor_b32 v207, 160, v200
    ds_read_b128 v[36:39], v207
    v_xor_b32 v208, 192, v200
    ds_read_b128 v[40:43], v208
    v_xor_b32 v209, 224, v200
    ds_read_b128 v[44:47], v209
    ds_read_b128 v[48:51], v201
    v_xor_b32 v207, 32, v201
    ds_read_b128 v[52:55], v207
    v_xor_b32 v208, 64, v201
    ds_read_b128 v[56:59], v208
    v_xor_b32 v209, 96, v201
    ds_read_b128 v[60:63], v209
    v_xor_b32 v206, 128, v201
    ds_read_b128 v[64:67], v206
    v_xor_b32 v207, 160, v201
    ds_read_b128 v[68:71], v207
    v_xor_b32 v208, 192, v201
    ds_read_b128 v[72:75], v208
    v_xor_b32 v209, 224, v201
    ds_read_b128 v[76:79], v209
    ds_read_b128 v[80:83], v202
    v_xor_b32 v207, 32, v202
    ds_read_b128 v[84:87], v207
    v_xor_b32 v208, 64, v202
    ds_read_b128 v[88:91], v208
    v_xor_b32 v209, 96, v202
    ds_read_b128 v[92:95], v209
    v_xor_b32 v206, 128, v202
    ds_read_b128 v[96:99], v206
    v_xor_b32 v207, 160, v202
    ds_read_b128 v[100:103], v207
    v_xor_b32 v208, 192, v202
    ds_read_b128 v[104:107], v208
    v_xor_b32 v209, 224, v202
    ds_read_b128 v[108:111], v209
    ds_read_b128 a[192:195], v184 offset:0
    ds_read_b128 a[196:199], v185 offset:0
    ds_read_b128 a[200:203], v186 offset:0
    ds_read_b128 a[204:207], v187 offset:0
    ds_read_b128 a[208:211], v188 offset:0
    ds_read_b128 a[212:215], v189 offset:0
    ds_read_b128 a[216:219], v190 offset:0
    ds_read_b128 a[220:223], v191 offset:0
    s_waitcnt lgkmcnt(0)
L_LOOP:
    v_mfma_f32_32x32x16_bf16 v[112:127], a[192:195], v[16:19], 0
    v_exp_f32 v144, v144
    v_exp_f32 v145, v145
    v_exp_f32 v146, v146
    v_exp_f32 v147, v147
    v_exp_f32 v148, v148
    v_mfma_f32_32x32x16_bf16 v[112:127], a[196:199], v[20:23], v[112:127]
    v_exp_f32 v149, v149
    v_exp_f32 v150, v150
    v_exp_f32 v151, v151
    v_exp_f32 v152, v152
    v_exp_f32 v153, v153
    v_mfma_f32_32x32x16_bf16 v[112:127], a[200:203], v[24:27], v[112:127]
    v_exp_f32 v154, v154
    v_exp_f32 v155, v155
    v_exp_f32 v156, v156
    v_exp_f32 v157, v157
    v_exp_f32 v158, v158
    v_mfma_f32_32x32x16_bf16 v[112:127], a[204:207], v[28:31], v[112:127]
    v_exp_f32 v159, v159
    v_cvt_pk_bf16_f32 v176, v144, v145
    v_cvt_pk_bf16_f32 v177, v146, v147
    v_cvt_pk_bf16_f32 v178, v148, v149
    v_cvt_pk_bf16_f32 v179, v150, v151
    v_mfma_f32_32x32x16_bf16 v[112:127], a[208:211], v[32:35], v[112:127]
    v_cvt_pk_bf16_f32 v180, v152, v153
    v_cvt_pk_bf16_f32 v181, v154, v155
    v_cvt_pk_bf16_f32 v182, v156, v157
    v_cvt_pk_bf16_f32 v183, v158, v159
    v_add_f32 v205, v144, v145
    v_mfma_f32_32x32x16_bf16 v[112:127], a[212:215], v[36:39], v[112:127]
    v_add_f32 v206, v146, v147
    v_add_f32 v205, v205, v148
    v_add_f32 v206, v206, v149
    v_add_f32 v205, v205, v150
    v_add_f32 v206, v206, v151
    v_mfma_f32_32x32x16_bf16 v[112:127], a[216:219], v[40:43], v[112:127]
    v_add_f32 v205, v205, v152
    v_add_f32 v206, v206, v153
    v_add_f32 v205, v205, v154
    v_add_f32 v206, v206, v155
    v_add_f32 v205, v205, v156
    v_mfma_f32_32x32x16_bf16 v[112:127], a[220:223], v[44:47], v[112:127]
    v_add_f32 v206, v206, v157
    v_add_f32 v205, v205, v158
    v_add_f32 v206, v206, v159
    v_add_f32 v205, v205, v206
    v_add_f32 v15, v15, v205
    v_mfma_f32_32x32x16_bf16 a[128:143], a[224:227], v[176:179], a[128:143]
    s_nop 7
    s_nop 2
    v_max3_f32 v196, v112, v113, v114
    v_max3_f32 v197, v115, v116, v117
    v_max3_f32 v196, v196, v118, v119
    v_mfma_f32_32x32x16_bf16 a[144:159], a[232:235], v[176:179], a[144:159]
    v_max3_f32 v197, v197, v120, v121
    v_max3_f32 v196, v196, v122, v123
    v_max3_f32 v197, v197, v124, v125
    v_max3_f32 v196, v196, v126, v127
    v_max_f32 v196, v196, v197
    v_mfma_f32_32x32x16_bf16 a[160:175], a[240:243], v[176:179], a[160:175]
    v_mov_b32 v197, v196
    s_nop 1
    v_permlane32_swap_b32 v196, v197
    s_nop 1
    v_mfma_f32_32x32x16_bf16 a[176:191], a[248:251], v[176:179], a[176:191]
    v_max_f32 v196, v196, v197
    v_mul_f32 v196, s37, v196
    v_sub_f32 v197, v196, v10
    v_cmp_lt_f32 vcc, s39, v197
    s_nop 4
    v_mfma_f32_32x32x16_bf16 a[128:143], a[228:231], v[180:183], a[128:143]
    s_cbranch_vccnz RESC_LA_0
    RET_LA_0:
    v_fma_f32 v112, v112, s37, -v10
    v_fma_f32 v113, v113, s37, -v10
    v_fma_f32 v114, v114, s37, -v10
    v_mfma_f32_32x32x16_bf16 a[144:159], a[236:239], v[180:183], a[144:159]
    v_fma_f32 v115, v115, s37, -v10
    v_fma_f32 v116, v116, s37, -v10
    v_fma_f32 v117, v117, s37, -v10
    v_fma_f32 v118, v118, s37, -v10
    v_mfma_f32_32x32x16_bf16 a[160:175], a[244:247], v[180:183], a[160:175]
    v_fma_f32 v119, v119, s37, -v10
    v_fma_f32 v120, v120, s37, -v10
    v_fma_f32 v121, v121, s37, -v10
    v_fma_f32 v122, v122, s37, -v10
    v_fma_f32 v123, v123, s37, -v10
    v_mfma_f32_32x32x16_bf16 a[176:191], a[252:255], v[180:183], a[176:191]
    v_fma_f32 v124, v124, s37, -v10
    v_fma_f32 v125, v125, s37, -v10
    v_fma_f32 v126, v126, s37, -v10
    v_fma_f32 v127, v127, s37, -v10
    v_mfma_f32_32x32x16_bf16 v[128:143], a[192:195], v[48:51], 0
    s_waitcnt vmcnt(16)
    ds_read_b64_tr_b16 a[224:225], v192 offset:16384
    ds_read_b64_tr_b16 a[226:227], v192 offset:18432
    ds_read_b64_tr_b16 a[232:233], v193 offset:16384
    ds_read_b64_tr_b16 a[234:235], v193 offset:18432
    ds_read_b64_tr_b16 a[240:241], v194 offset:16384
    ds_read_b64_tr_b16 a[242:243], v194 offset:18432
    ds_read_b64_tr_b16 a[248:249], v195 offset:16384
    ds_read_b64_tr_b16 a[250:251], v195 offset:18432
    ds_read_b64_tr_b16 a[228:229], v192 offset:20480
    v_mfma_f32_32x32x16_bf16 v[128:143], a[196:199], v[52:55], v[128:143]
    ds_read_b64_tr_b16 a[230:231], v192 offset:22528
    ds_read_b64_tr_b16 a[236:237], v193 offset:20480
    ds_read_b64_tr_b16 a[238:239], v193 offset:22528
    ds_read_b64_tr_b16 a[244:245], v194 offset:20480
    ds_read_b64_tr_b16 a[246:247], v194 offset:22528
    ds_read_b64_tr_b16 a[252:253], v195 offset:20480
    ds_read_b64_tr_b16 a[254:255], v195 offset:22528
    s_add_u32 m0, s31, 0
    s_add_u32 s47, s33, s52
    v_mfma_f32_32x32x16_bf16 v[128:143], a[200:203], v[56:59], v[128:143]
    s_cmp_lt_u32 s38, 14
    s_cselect_b32 s47, s47, s53
    s_add_u32 s35, s47, 4096
    buffer_load_dwordx4 v2, s[16:19], s47 offen offset:0 nt lds
    buffer_load_dwordx4 v3, s[16:19], s47 offen offset:1024 nt lds
    buffer_load_dwordx4 v4, s[16:19], s47 offen offset:2048 nt lds
    buffer_load_dwordx4 v5, s[16:19], s47 offen offset:3072 nt lds
    s_add_u32 m0, s31, 4096
    s_nop 0
    v_mfma_f32_32x32x16_bf16 v[128:143], a[204:207], v[60:63], v[128:143]
    buffer_load_dwordx4 v2, s[16:19], s35 offen offset:0 nt lds
    buffer_load_dwordx4 v3, s[16:19], s35 offen offset:1024 nt lds
    buffer_load_dwordx4 v4, s[16:19], s35 offen offset:2048 nt lds
    buffer_load_dwordx4 v5, s[16:19], s35 offen offset:3072 nt lds
    s_add_u32 s33, s33, 32768
    v_exp_f32 v112, v112
    v_exp_f32 v113, v113
    v_exp_f32 v114, v114
    v_exp_f32 v115, v115
    v_mfma_f32_32x32x16_bf16 v[128:143], a[208:211], v[64:67], v[128:143]
    v_exp_f32 v116, v116
    v_exp_f32 v117, v117
    v_exp_f32 v118, v118
    v_exp_f32 v119, v119
    v_exp_f32 v120, v120
    v_exp_f32 v121, v121
    v_exp_f32 v122, v122
    v_exp_f32 v123, v123
    v_exp_f32 v124, v124
    v_exp_f32 v125, v125
    v_mfma_f32_32x32x16_bf16 v[128:143], a[212:215], v[68:71], v[128:143]
    v_exp_f32 v126, v126
    v_exp_f32 v127, v127
    v_cvt_pk_bf16_f32 v160, v112, v113
    v_cvt_pk_bf16_f32 v161, v114, v115
    v_cvt_pk_bf16_f32 v162, v116, v117
    v_cvt_pk_bf16_f32 v163, v118, v119
    v_cvt_pk_bf16_f32 v164, v120, v121
    v_cvt_pk_bf16_f32 v165, v122, v123
    v_cvt_pk_bf16_f32 v166, v124, v125
    v_mfma_f32_32x32x16_bf16 v[128:143], a[216:219], v[72:75], v[128:143]
    v_cvt_pk_bf16_f32 v167, v126, v127
    v_add_f32 v197, v112, v113
    v_add_f32 v198, v114, v115
    v_add_f32 v197, v197, v116
    v_add_f32 v198, v198, v117
    v_add_f32 v197, v197, v118
    v_add_f32 v198, v198, v119
    v_add_f32 v197, v197, v120
    v_add_f32 v198, v198, v121
    v_mfma_f32_32x32x16_bf16 v[128:143], a[220:223], v[76:79], v[128:143]
    v_add_f32 v197, v197, v122
    v_add_f32 v198, v198, v123
    v_add_f32 v197, v197, v124
    v_add_f32 v198, v198, v125
    v_add_f32 v197, v197, v126
    v_add_f32 v198, v198, v127
    v_add_f32 v197, v197, v198
    v_add_f32 v13, v13, v197
    s_waitcnt lgkmcnt(0)
    v_mfma_f32_32x32x16_bf16 a[0:15], a[224:227], v[160:163], a[0:15]
    s_nop 7
    s_nop 2
    v_max3_f32 v200, v128, v129, v130
    v_max3_f32 v201, v131, v132, v133
    v_max3_f32 v200, v200, v134, v135
    v_mfma_f32_32x32x16_bf16 a[16:31], a[232:235], v[160:163], a[16:31]
    v_max3_f32 v201, v201, v136, v137
    v_max3_f32 v200, v200, v138, v139
    v_max3_f32 v201, v201, v140, v141
    v_max3_f32 v200, v200, v142, v143
    v_max_f32 v200, v200, v201
    v_mfma_f32_32x32x16_bf16 a[32:47], a[240:243], v[160:163], a[32:47]
    v_mov_b32 v201, v200
    s_nop 1
    v_permlane32_swap_b32 v200, v201
    s_nop 1
    v_mfma_f32_32x32x16_bf16 a[48:63], a[248:251], v[160:163], a[48:63]
    v_max_f32 v200, v200, v201
    v_mul_f32 v200, s37, v200
    v_sub_f32 v201, v200, v11
    v_cmp_lt_f32 vcc, s39, v201
    s_nop 4
    v_mfma_f32_32x32x16_bf16 a[0:15], a[228:231], v[164:167], a[0:15]
    s_cbranch_vccnz RESC_LA_1
    RET_LA_1:
    v_fma_f32 v128, v128, s37, -v11
    v_fma_f32 v129, v129, s37, -v11
    v_fma_f32 v130, v130, s37, -v11
    v_mfma_f32_32x32x16_bf16 a[16:31], a[236:239], v[164:167], a[16:31]
    v_fma_f32 v131, v131, s37, -v11
    v_fma_f32 v132, v132, s37, -v11
    v_fma_f32 v133, v133, s37, -v11
    v_fma_f32 v134, v134, s37, -v11
    v_mfma_f32_32x32x16_bf16 a[32:47], a[244:247], v[164:167], a[32:47]
    v_fma_f32 v135, v135, s37, -v11
    v_fma_f32 v136, v136, s37, -v11
    v_fma_f32 v137, v137, s37, -v11
    v_fma_f32 v138, v138, s37, -v11
    v_fma_f32 v139, v139, s37, -v11
    v_mfma_f32_32x32x16_bf16 a[48:63], a[252:255], v[164:167], a[48:63]
    v_fma_f32 v140, v140, s37, -v11
    v_fma_f32 v141, v141, s37, -v11
    v_fma_f32 v142, v142, s37, -v11
    v_fma_f32 v143, v143, s37, -v11
    v_mfma_f32_32x32x16_bf16 v[144:159], a[192:195], v[80:83], 0
    v_exp_f32 v128, v128
    v_exp_f32 v129, v129
    v_exp_f32 v130, v130
    v_exp_f32 v131, v131
    v_exp_f32 v132, v132
    v_mfma_f32_32x32x16_bf16 v[144:159], a[196:199], v[84:87], v[144:159]
    v_exp_f32 v133, v133
    v_exp_f32 v134, v134
    v_exp_f32 v135, v135
    v_exp_f32 v136, v136
    v_exp_f32 v137, v137
    v_mfma_f32_32x32x16_bf16 v[144:159], a[200:203], v[88:91], v[144:159]
    v_exp_f32 v138, v138
    v_exp_f32 v139, v139
    v_exp_f32 v140, v140
    v_exp_f32 v141, v141
    v_exp_f32 v142, v142
    v_mfma_f32_32x32x16_bf16 v[144:159], a[204:207], v[92:95], v[144:159]
    v_exp_f32 v143, v143
    v_cvt_pk_bf16_f32 v168, v128, v129
    v_cvt_pk_bf16_f32 v169, v130, v131
    v_cvt_pk_bf16_f32 v170, v132, v133
    v_cvt_pk_bf16_f32 v171, v134, v135
    v_mfma_f32_32x32x16_bf16 v[144:159], a[208:211], v[96:99], v[144:159]
    v_cvt_pk_bf16_f32 v172, v136, v137
    v_cvt_pk_bf16_f32 v173, v138, v139
    v_cvt_pk_bf16_f32 v174, v140, v141
    v_cvt_pk_bf16_f32 v175, v142, v143
    v_add_f32 v201, v128, v129
    v_mfma_f32_32x32x16_bf16 v[144:159], a[212:215], v[100:103], v[144:159]
    v_add_f32 v202, v130, v131
    v_add_f32 v201, v201, v132
    v_add_f32 v202, v202, v133
    v_add_f32 v201, v201, v134
    v_add_f32 v202, v202, v135
    v_mfma_f32_32x32x16_bf16 v[144:159], a[216:219], v[104:107], v[144:159]
    v_add_f32 v201, v201, v136
    v_add_f32 v202, v202, v137
    v_add_f32 v201, v201, v138
    v_add_f32 v202, v202, v139
    v_add_f32 v201, v201, v140
    v_mfma_f32_32x32x16_bf16 v[144:159], a[220:223], v[108:111], v[144:159]
    v_add_f32 v202, v202, v141
    v_add_f32 v201, v201, v142
    v_add_f32 v202, v202, v143
    v_add_f32 v201, v201, v202
    v_add_f32 v14, v14, v201
    v_mfma_f32_32x32x16_bf16 a[64:79], a[224:227], v[168:171], a[64:79]
    s_waitcnt vmcnt(16)
    ds_read_b128 a[192:195], v184 offset:8192
    ds_read_b128 a[196:199], v185 offset:8192
    ds_read_b128 a[200:203], v186 offset:8192
    ds_read_b128 a[204:207], v187 offset:8192
    ds_read_b128 a[208:211], v188 offset:8192
    ds_read_b128 a[212:215], v189 offset:8192
    ds_read_b128 a[216:219], v190 offset:8192
    v_mfma_f32_32x32x16_bf16 a[80:95], a[232:235], v[168:171], a[80:95]
    ds_read_b128 a[220:223], v191 offset:8192
    s_add_u32 m0, s31, 16384
    s_add_u32 s47, s34, s52
    s_cmp_lt_u32 s38, 14
    s_cselect_b32 s47, s47, s53
    s_add_u32 s35, s47, 4096
    buffer_load_dwordx4 v6, s[20:23], s47 offen offset:0 nt lds
    buffer_load_dwordx4 v6, s[20:23], s47 offen offset:1024 nt lds
    v_mfma_f32_32x32x16_bf16 a[96:111], a[240:243], v[168:171], a[96:111]
    buffer_load_dwordx4 v6, s[20:23], s47 offen offset:2048 nt lds
    buffer_load_dwordx4 v6, s[20:23], s47 offen offset:3072 nt lds
    s_add_u32 m0, s31, 20480
    s_nop 0
    buffer_load_dwordx4 v6, s[20:23], s35 offen offset:0 nt lds
    buffer_load_dwordx4 v6, s[20:23], s35 offen offset:1024 nt lds
    buffer_load_dwordx4 v6, s[20:23], s35 offen offset:2048 nt lds
    buffer_load_dwordx4 v6, s[20:23], s35 offen offset:3072 nt lds
    v_mfma_f32_32x32x16_bf16 a[112:127], a[248:251], v[168:171], a[112:127]
    s_add_u32 s34, s34, 32768
    v_max3_f32 v204, v144, v145, v146
    v_max3_f32 v205, v147, v148, v149
    v_max3_f32 v204, v204, v150, v151
    v_max3_f32 v205, v205, v152, v153
    v_max3_f32 v204, v204, v154, v155
    v_max3_f32 v205, v205, v156, v157
    v_mfma_f32_32x32x16_bf16 a[64:79], a[228:231], v[172:175], a[64:79]
    v_max3_f32 v204, v204, v158, v159
    v_max_f32 v204, v204, v205
    v_mov_b32 v205, v204
    s_nop 1
    v_permlane32_swap_b32 v204, v205
    s_nop 1
    v_max_f32 v204, v204, v205
    v_mul_f32 v204, s37, v204
    v_mfma_f32_32x32x16_bf16 a[80:95], a[236:239], v[172:175], a[80:95]
    v_sub_f32 v205, v204, v12
    v_cmp_lt_f32 vcc, s39, v205
    s_nop 4
    s_cbranch_vccnz RESC_LA_2
    RET_LA_2:
    v_fma_f32 v144, v144, s37, -v12
    v_fma_f32 v145, v145, s37, -v12
    v_fma_f32 v146, v146, s37, -v12
    v_mfma_f32_32x32x16_bf16 a[96:111], a[244:247], v[172:175], a[96:111]
    v_fma_f32 v147, v147, s37, -v12
    v_fma_f32 v148, v148, s37, -v12
    v_fma_f32 v149, v149, s37, -v12
    v_fma_f32 v150, v150, s37, -v12
    v_fma_f32 v151, v151, s37, -v12
    v_fma_f32 v152, v152, s37, -v12
    v_fma_f32 v153, v153, s37, -v12
    v_fma_f32 v154, v154, s37, -v12
    v_mfma_f32_32x32x16_bf16 a[112:127], a[252:255], v[172:175], a[112:127]
    v_fma_f32 v155, v155, s37, -v12
    v_fma_f32 v156, v156, s37, -v12
    v_fma_f32 v157, v157, s37, -v12
    v_fma_f32 v158, v158, s37, -v12
    v_fma_f32 v159, v159, s37, -v12
    s_waitcnt lgkmcnt(0)
    s_add_u32 s38, s38, 1
    v_mfma_f32_32x32x16_bf16 v[112:127], a[192:195], v[16:19], 0
    v_exp_f32 v144, v144
    v_exp_f32 v145, v145
    v_exp_f32 v146, v146
    v_exp_f32 v147, v147
    v_exp_f32 v148, v148
    v_mfma_f32_32x32x16_bf16 v[112:127], a[196:199], v[20:23], v[112:127]
    v_exp_f32 v149, v149
    v_exp_f32 v150, v150
    v_exp_f32 v151, v151
    v_exp_f32 v152, v152
    v_exp_f32 v153, v153
    v_mfma_f32_32x32x16_bf16 v[112:127], a[200:203], v[24:27], v[112:127]
    v_exp_f32 v154, v154
    v_exp_f32 v155, v155
    v_exp_f32 v156, v156
    v_exp_f32 v157, v157
    v_exp_f32 v158, v158
    v_mfma_f32_32x32x16_bf16 v[112:127], a[204:207], v[28:31], v[112:127]
    v_exp_f32 v159, v159
    v_cvt_pk_bf16_f32 v176, v144, v145
    v_cvt_pk_bf16_f32 v177, v146, v147
    v_cvt_pk_bf16_f32 v178, v148, v149
    v_cvt_pk_bf16_f32 v179, v150, v151
    v_mfma_f32_32x32x16_bf16 v[112:127], a[208:211], v[32:35], v[112:127]
    v_cvt_pk_bf16_f32 v180, v152, v153
    v_cvt_pk_bf16_f32 v181, v154, v155
    v_cvt_pk_bf16_f32 v182, v156, v157
    v_cvt_pk_bf16_f32 v183, v158, v159
    v_add_f32 v205, v144, v145
    v_mfma_f32_32x32x16_bf16 v[112:127], a[212:215], v[36:39], v[112:127]
    v_add_f32 v206, v146, v147
    v_add_f32 v205, v205, v148
    v_add_f32 v206, v206, v149
    v_add_f32 v205, v205, v150
    v_add_f32 v206, v206, v151
    v_mfma_f32_32x32x16_bf16 v[112:127], a[216:219], v[40:43], v[112:127]
    v_add_f32 v205, v205, v152
    v_add_f32 v206, v206, v153
    v_add_f32 v205, v205, v154
    v_add_f32 v206, v206, v155
    v_add_f32 v205, v205, v156
    v_mfma_f32_32x32x16_bf16 v[112:127], a[220:223], v[44:47], v[112:127]
    v_add_f32 v206, v206, v157
    v_add_f32 v205, v205, v158
    v_add_f32 v206, v206, v159
    v_add_f32 v205, v205, v206
    v_add_f32 v15, v15, v205
    v_mfma_f32_32x32x16_bf16 a[128:143], a[224:227], v[176:179], a[128:143]
    s_nop 7
    s_nop 2
    v_max3_f32 v196, v112, v113, v114
    v_max3_f32 v197, v115, v116, v117
    v_max3_f32 v196, v196, v118, v119
    v_mfma_f32_32x32x16_bf16 a[144:159], a[232:235], v[176:179], a[144:159]
    v_max3_f32 v197, v197, v120, v121
    v_max3_f32 v196, v196, v122, v123
    v_max3_f32 v197, v197, v124, v125
    v_max3_f32 v196, v196, v126, v127
    v_max_f32 v196, v196, v197
    v_mfma_f32_32x32x16_bf16 a[160:175], a[240:243], v[176:179], a[160:175]
    v_mov_b32 v197, v196
    s_nop 1
    v_permlane32_swap_b32 v196, v197
    s_nop 1
    v_mfma_f32_32x32x16_bf16 a[176:191], a[248:251], v[176:179], a[176:191]
    v_max_f32 v196, v196, v197
    v_mul_f32 v196, s37, v196
    v_sub_f32 v197, v196, v10
    v_cmp_lt_f32 vcc, s39, v197
    s_nop 4
    v_mfma_f32_32x32x16_bf16 a[128:143], a[228:231], v[180:183], a[128:143]
    s_cbranch_vccnz RESC_LB_0
    RET_LB_0:
    v_fma_f32 v112, v112, s37, -v10
    v_fma_f32 v113, v113, s37, -v10
    v_fma_f32 v114, v114, s37, -v10
    v_mfma_f32_32x32x16_bf16 a[144:159], a[236:239], v[180:183], a[144:159]
    v_fma_f32 v115, v115, s37, -v10
    v_fma_f32 v116, v116, s37, -v10
    v_fma_f32 v117, v117, s37, -v10
    v_fma_f32 v118, v118, s37, -v10
    v_mfma_f32_32x32x16_bf16 a[160:175], a[244:247], v[180:183], a[160:175]
    v_fma_f32 v119, v119, s37, -v10
    v_fma_f32 v120, v120, s37, -v10
    v_fma_f32 v121, v121, s37, -v10
    v_fma_f32 v122, v122, s37, -v10
    v_fma_f32 v123, v123, s37, -v10
    v_mfma_f32_32x32x16_bf16 a[176:191], a[252:255], v[180:183], a[176:191]
    v_fma_f32 v124, v124, s37, -v10
    v_fma_f32 v125, v125, s37, -v10
    v_fma_f32 v126, v126, s37, -v10
    v_fma_f32 v127, v127, s37, -v10
    v_mfma_f32_32x32x16_bf16 v[128:143], a[192:195], v[48:51], 0
    s_waitcnt vmcnt(16)
    ds_read_b64_tr_b16 a[224:225], v192 offset:24576
    ds_read_b64_tr_b16 a[226:227], v192 offset:26624
    ds_read_b64_tr_b16 a[232:233], v193 offset:24576
    ds_read_b64_tr_b16 a[234:235], v193 offset:26624
    ds_read_b64_tr_b16 a[240:241], v194 offset:24576
    ds_read_b64_tr_b16 a[242:243], v194 offset:26624
    ds_read_b64_tr_b16 a[248:249], v195 offset:24576
    ds_read_b64_tr_b16 a[250:251], v195 offset:26624
    ds_read_b64_tr_b16 a[228:229], v192 offset:28672
    v_mfma_f32_32x32x16_bf16 v[128:143], a[196:199], v[52:55], v[128:143]
    ds_read_b64_tr_b16 a[230:231], v192 offset:30720
    ds_read_b64_tr_b16 a[236:237], v193 offset:28672
    ds_read_b64_tr_b16 a[238:239], v193 offset:30720
    ds_read_b64_tr_b16 a[244:245], v194 offset:28672
    ds_read_b64_tr_b16 a[246:247], v194 offset:30720
    ds_read_b64_tr_b16 a[252:253], v195 offset:28672
    ds_read_b64_tr_b16 a[254:255], v195 offset:30720
    s_add_u32 m0, s31, 8192
    s_add_u32 s47, s33, s52
    v_mfma_f32_32x32x16_bf16 v[128:143], a[200:203], v[56:59], v[128:143]
    s_cmp_lt_u32 s38, 14
    s_cselect_b32 s47, s47, s53
    s_add_u32 s35, s47, 4096
    buffer_load_dwordx4 v2, s[16:19], s47 offen offset:0 nt lds
    buffer_load_dwordx4 v3, s[16:19], s47 offen offset:1024 nt lds
    buffer_load_dwordx4 v4, s[16:19], s47 offen offset:2048 nt lds
    buffer_load_dwordx4 v5, s[16:19], s47 offen offset:3072 nt lds
    s_add_u32 m0, s31, 12288
    s_nop 0
    v_mfma_f32_32x32x16_bf16 v[128:143], a[204:207], v[60:63], v[128:143]
    buffer_load_dwordx4 v2, s[16:19], s35 offen offset:0 nt lds
    buffer_load_dwordx4 v3, s[16:19], s35 offen offset:1024 nt lds
    buffer_load_dwordx4 v4, s[16:19], s35 offen offset:2048 nt lds
    buffer_load_dwordx4 v5, s[16:19], s35 offen offset:3072 nt lds
    s_add_u32 s33, s33, 32768
    v_exp_f32 v112, v112
    v_exp_f32 v113, v113
    v_exp_f32 v114, v114
    v_exp_f32 v115, v115
    v_mfma_f32_32x32x16_bf16 v[128:143], a[208:211], v[64:67], v[128:143]
    v_exp_f32 v116, v116
    v_exp_f32 v117, v117
    v_exp_f32 v118, v118
    v_exp_f32 v119, v119
    v_exp_f32 v120, v120
    v_exp_f32 v121, v121
    v_exp_f32 v122, v122
    v_exp_f32 v123, v123
    v_exp_f32 v124, v124
    v_exp_f32 v125, v125
    v_mfma_f32_32x32x16_bf16 v[128:143], a[212:215], v[68:71], v[128:143]
    v_exp_f32 v126, v126
    v_exp_f32 v127, v127
    v_cvt_pk_bf16_f32 v160, v112, v113
    v_cvt_pk_bf16_f32 v161, v114, v115
    v_cvt_pk_bf16_f32 v162, v116, v117
    v_cvt_pk_bf16_f32 v163, v118, v119
    v_cvt_pk_bf16_f32 v164, v120, v121
    v_cvt_pk_bf16_f32 v165, v122, v123
    v_cvt_pk_bf16_f32 v166, v124, v125
    v_mfma_f32_32x32x16_bf16 v[128:143], a[216:219], v[72:75], v[128:143]
    v_cvt_pk_bf16_f32 v167, v126, v127
    v_add_f32 v197, v112, v113
    v_add_f32 v198, v114, v115
    v_add_f32 v197, v197, v116
    v_add_f32 v198, v198, v117
    v_add_f32 v197, v197, v118
    v_add_f32 v198, v198, v119
    v_add_f32 v197, v197, v120
    v_add_f32 v198, v198, v121
    v_mfma_f32_32x32x16_bf16 v[128:143], a[220:223], v[76:79], v[128:143]
    v_add_f32 v197, v197, v122
    v_add_f32 v198, v198, v123
    v_add_f32 v197, v197, v124
    v_add_f32 v198, v198, v125
    v_add_f32 v197, v197, v126
    v_add_f32 v198, v198, v127
    v_add_f32 v197, v197, v198
    v_add_f32 v13, v13, v197
    s_waitcnt lgkmcnt(0)
    v_mfma_f32_32x32x16_bf16 a[0:15], a[224:227], v[160:163], a[0:15]
    s_nop 7
    s_nop 2
    v_max3_f32 v200, v128, v129, v130
    v_max3_f32 v201, v131, v132, v133
    v_max3_f32 v200, v200, v134, v135
    v_mfma_f32_32x32x16_bf16 a[16:31], a[232:235], v[160:163], a[16:31]
    v_max3_f32 v201, v201, v136, v137
    v_max3_f32 v200, v200, v138, v139
    v_max3_f32 v201, v201, v140, v141
    v_max3_f32 v200, v200, v142, v143
    v_max_f32 v200, v200, v201
    v_mfma_f32_32x32x16_bf16 a[32:47], a[240:243], v[160:163], a[32:47]
    v_mov_b32 v201, v200
    s_nop 1
    v_permlane32_swap_b32 v200, v201
    s_nop 1
    v_mfma_f32_32x32x16_bf16 a[48:63], a[248:251], v[160:163], a[48:63]
    v_max_f32 v200, v200, v201
    v_mul_f32 v200, s37, v200
    v_sub_f32 v201, v200, v11
    v_cmp_lt_f32 vcc, s39, v201
    s_nop 4
    v_mfma_f32_32x32x16_bf16 a[0:15], a[228:231], v[164:167], a[0:15]
    s_cbranch_vccnz RESC_LB_1
    RET_LB_1:
    v_fma_f32 v128, v128, s37, -v11
    v_fma_f32 v129, v129, s37, -v11
    v_fma_f32 v130, v130, s37, -v11
    v_mfma_f32_32x32x16_bf16 a[16:31], a[236:239], v[164:167], a[16:31]
    v_fma_f32 v131, v131, s37, -v11
    v_fma_f32 v132, v132, s37, -v11
    v_fma_f32 v133, v133, s37, -v11
    v_fma_f32 v134, v134, s37, -v11
    v_mfma_f32_32x32x16_bf16 a[32:47], a[244:247], v[164:167], a[32:47]
    v_fma_f32 v135, v135, s37, -v11
    v_fma_f32 v136, v136, s37, -v11
    v_fma_f32 v137, v137, s37, -v11
    v_fma_f32 v138, v138, s37, -v11
    v_fma_f32 v139, v139, s37, -v11
    v_mfma_f32_32x32x16_bf16 a[48:63], a[252:255], v[164:167], a[48:63]
    v_fma_f32 v140, v140, s37, -v11
    v_fma_f32 v141, v141, s37, -v11
    v_fma_f32 v142, v142, s37, -v11
    v_fma_f32 v143, v143, s37, -v11
    v_mfma_f32_32x32x16_bf16 v[144:159], a[192:195], v[80:83], 0
    v_exp_f32 v128, v128
    v_exp_f32 v129, v129
    v_exp_f32 v130, v130
    v_exp_f32 v131, v131
    v_exp_f32 v132, v132
    v_mfma_f32_32x32x16_bf16 v[144:159], a[196:199], v[84:87], v[144:159]
    v_exp_f32 v133, v133
    v_exp_f32 v134, v134
    v_exp_f32 v135, v135
    v_exp_f32 v136, v136
    v_exp_f32 v137, v137
    v_mfma_f32_32x32x16_bf16 v[144:159], a[200:203], v[88:91], v[144:159]
    v_exp_f32 v138, v138
    v_exp_f32 v139, v139
    v_exp_f32 v140, v140
    v_exp_f32 v141, v141
    v_exp_f32 v142, v142
    v_mfma_f32_32x32x16_bf16 v[144:159], a[204:207], v[92:95], v[144:159]
    v_exp_f32 v143, v143
    v_cvt_pk_bf16_f32 v168, v128, v129
    v_cvt_pk_bf16_f32 v169, v130, v131
    v_cvt_pk_bf16_f32 v170, v132, v133
    v_cvt_pk_bf16_f32 v171, v134, v135
    v_mfma_f32_32x32x16_bf16 v[144:159], a[208:211], v[96:99], v[144:159]
    v_cvt_pk_bf16_f32 v172, v136, v137
    v_cvt_pk_bf16_f32 v173, v138, v139
    v_cvt_pk_bf16_f32 v174, v140, v141
    v_cvt_pk_bf16_f32 v175, v142, v143
    v_add_f32 v201, v128, v129
    v_mfma_f32_32x32x16_bf16 v[144:159], a[212:215], v[100:103], v[144:159]
    v_add_f32 v202, v130, v131
    v_add_f32 v201, v201, v132
    v_add_f32 v202, v202, v133
    v_add_f32 v201, v201, v134
    v_add_f32 v202, v202, v135
    v_mfma_f32_32x32x16_bf16 v[144:159], a[216:219], v[104:107], v[144:159]
    v_add_f32 v201, v201, v136
    v_add_f32 v202, v202, v137
    v_add_f32 v201, v201, v138
    v_add_f32 v202, v202, v139
    v_add_f32 v201, v201, v140
    v_mfma_f32_32x32x16_bf16 v[144:159], a[220:223], v[108:111], v[144:159]
    v_add_f32 v202, v202, v141
    v_add_f32 v201, v201, v142
    v_add_f32 v202, v202, v143
    v_add_f32 v201, v201, v202
    v_add_f32 v14, v14, v201
    v_mfma_f32_32x32x16_bf16 a[64:79], a[224:227], v[168:171], a[64:79]
    s_waitcnt vmcnt(16)
    ds_read_b128 a[192:195], v184 offset:0
    ds_read_b128 a[196:199], v185 offset:0
    ds_read_b128 a[200:203], v186 offset:0
    ds_read_b128 a[204:207], v187 offset:0
    ds_read_b128 a[208:211], v188 offset:0
    ds_read_b128 a[212:215], v189 offset:0
    ds_read_b128 a[216:219], v190 offset:0
    v_mfma_f32_32x32x16_bf16 a[80:95], a[232:235], v[168:171], a[80:95]
    ds_read_b128 a[220:223], v191 offset:0
    s_add_u32 m0, s31, 24576
    s_add_u32 s47, s34, s52
    s_cmp_lt_u32 s38, 14
    s_cselect_b32 s47, s47, s53
    s_add_u32 s35, s47, 4096
    buffer_load_dwordx4 v6, s[20:23], s47 offen offset:0 nt lds
    buffer_load_dwordx4 v6, s[20:23], s47 offen offset:1024 nt lds
    v_mfma_f32_32x32x16_bf16 a[96:111], a[240:243], v[168:171], a[96:111]
    buffer_load_dwordx4 v6, s[20:23], s47 offen offset:2048 nt lds
    buffer_load_dwordx4 v6, s[20:23], s47 offen offset:3072 nt lds
    s_add_u32 m0, s31, 28672
    s_nop 0
    buffer_load_dwordx4 v6, s[20:23], s35 offen offset:0 nt lds
    buffer_load_dwordx4 v6, s[20:23], s35 offen offset:1024 nt lds
    buffer_load_dwordx4 v6, s[20:23], s35 offen offset:2048 nt lds
    buffer_load_dwordx4 v6, s[20:23], s35 offen offset:3072 nt lds
    v_mfma_f32_32x32x16_bf16 a[112:127], a[248:251], v[168:171], a[112:127]
    s_add_u32 s34, s34, 32768
    v_max3_f32 v204, v144, v145, v146
    v_max3_f32 v205, v147, v148, v149
    v_max3_f32 v204, v204, v150, v151
    v_max3_f32 v205, v205, v152, v153
    v_max3_f32 v204, v204, v154, v155
    v_max3_f32 v205, v205, v156, v157
    v_mfma_f32_32x32x16_bf16 a[64:79], a[228:231], v[172:175], a[64:79]
    v_max3_f32 v204, v204, v158, v159
    v_max_f32 v204, v204, v205
    v_mov_b32 v205, v204
    s_nop 1
    v_permlane32_swap_b32 v204, v205
    s_nop 1
    v_max_f32 v204, v204, v205
    v_mul_f32 v204, s37, v204
    v_mfma_f32_32x32x16_bf16 a[80:95], a[236:239], v[172:175], a[80:95]
    v_sub_f32 v205, v204, v12
    v_cmp_lt_f32 vcc, s39, v205
    s_nop 4
    s_cbranch_vccnz RESC_LB_2
    RET_LB_2:
    v_fma_f32 v144, v144, s37, -v12
    v_fma_f32 v145, v145, s37, -v12
    v_fma_f32 v146, v146, s37, -v12
    v_mfma_f32_32x32x16_bf16 a[96:111], a[244:247], v[172:175], a[96:111]
    v_fma_f32 v147, v147, s37, -v12
    v_fma_f32 v148, v148, s37, -v12
    v_fma_f32 v149, v149, s37, -v12
    v_fma_f32 v150, v150, s37, -v12
    v_fma_f32 v151, v151, s37, -v12
    v_fma_f32 v152, v152, s37, -v12
    v_fma_f32 v153, v153, s37, -v12
    v_fma_f32 v154, v154, s37, -v12
    v_mfma_f32_32x32x16_bf16 a[112:127], a[252:255], v[172:175], a[112:127]
    v_fma_f32 v155, v155, s37, -v12
    v_fma_f32 v156, v156, s37, -v12
    v_fma_f32 v157, v157, s37, -v12
    v_fma_f32 v158, v158, s37, -v12
    v_fma_f32 v159, v159, s37, -v12
    s_waitcnt lgkmcnt(0)
    s_add_u32 s38, s38, 1
    s_cmp_lt_u32 s38, 16
    s_cbranch_scc1 L_LOOP
    v_exp_f32 v144, v144
    v_exp_f32 v145, v145
    v_exp_f32 v146, v146
    v_exp_f32 v147, v147
    v_exp_f32 v148, v148
    v_exp_f32 v149, v149
    v_exp_f32 v150, v150
    v_exp_f32 v151, v151
    v_exp_f32 v152, v152
    v_exp_f32 v153, v153
    v_exp_f32 v154, v154
    v_exp_f32 v155, v155
    v_exp_f32 v156, v156
    v_exp_f32 v157, v157
    v_exp_f32 v158, v158
    v_exp_f32 v159, v159
    v_cvt_pk_bf16_f32 v176, v144, v145
    v_cvt_pk_bf16_f32 v177, v146, v147
    v_cvt_pk_bf16_f32 v178, v148, v149
    v_cvt_pk_bf16_f32 v179, v150, v151
    v_cvt_pk_bf16_f32 v180, v152, v153
    v_cvt_pk_bf16_f32 v181, v154, v155
    v_cvt_pk_bf16_f32 v182, v156, v157
    v_cvt_pk_bf16_f32 v183, v158, v159
    v_add_f32 v205, v144, v145
    v_add_f32 v206, v146, v147
    v_add_f32 v205, v205, v148
    v_add_f32 v206, v206, v149
    v_add_f32 v205, v205, v150
    v_add_f32 v206, v206, v151
    v_add_f32 v205, v205, v152
    v_add_f32 v206, v206, v153
    v_add_f32 v205, v205, v154
    v_add_f32 v206, v206, v155
    v_add_f32 v205, v205, v156
    v_add_f32 v206, v206, v157
    v_add_f32 v205, v205, v158
    v_add_f32 v206, v206, v159
    v_add_f32 v205, v205, v206
    v_add_f32 v15, v15, v205
    s_nop 1
    v_mfma_f32_32x32x16_bf16 a[128:143], a[224:227], v[176:179], a[128:143]
    v_mfma_f32_32x32x16_bf16 a[144:159], a[232:235], v[176:179], a[144:159]
    v_mfma_f32_32x32x16_bf16 a[160:175], a[240:243], v[176:179], a[160:175]
    v_mfma_f32_32x32x16_bf16 a[176:191], a[248:251], v[176:179], a[176:191]
    v_mfma_f32_32x32x16_bf16 a[128:143], a[228:231], v[180:183], a[128:143]
    v_mfma_f32_32x32x16_bf16 a[144:159], a[236:239], v[180:183], a[144:159]
    v_mfma_f32_32x32x16_bf16 a[160:175], a[244:247], v[180:183], a[160:175]
    v_mfma_f32_32x32x16_bf16 a[176:191], a[252:255], v[180:183], a[176:191]
    v_mov_b32 v196, v13
    v_mov_b32 v197, v14
    v_mov_b32 v198, v15
    s_nop 1
    v_permlane32_swap_b32 v13, v196
    v_permlane32_swap_b32 v14, v197
    v_permlane32_swap_b32 v15, v198
    s_nop 1
    v_add_f32 v13, v13, v196
    v_add_f32 v14, v14, v197
    v_add_f32 v15, v15, v198
    v_lshlrev_b32 v184, 2, v1
    v_add_u32 v185, s31, v184
    s_waitcnt vmcnt(0)
    ds_write_b32 v185, v10 offset:38912
    ds_write_b32 v185, v13 offset:39680
    ds_write_b32 v185, v11 offset:39168
    ds_write_b32 v185, v14 offset:39936
    ds_write_b32 v185, v12 offset:39424
    ds_write_b32 v185, v15 offset:40192
    v_add_u32 v244, 0, v184
    v_add_u32 v245, 40960, v184
    v_add_u32 v246, 81920, v184
    v_add_u32 v247, 122880, v184
    v_lshlrev_b32 v248, 4, v1
    s_cmp_eq_u32 s30, 0
    s_cbranch_scc1 L_SKIPW0
    s_sub_u32 s54, 3, s30
    s_and_b32 s54, s54, 3
    s_mul_i32 s54, s54, 12288
    s_add_u32 s54, s54, s31
    v_add_u32 v249, s54, v248
    ds_write_b128 v249, a[0:3] offset:0
    ds_write_b128 v249, a[4:7] offset:1024
    ds_write_b128 v249, a[8:11] offset:2048
    ds_write_b128 v249, a[12:15] offset:3072
    ds_write_b128 v249, a[64:67] offset:4096
    ds_write_b128 v249, a[68:71] offset:5120
    ds_write_b128 v249, a[72:75] offset:6144
    ds_write_b128 v249, a[76:79] offset:7168
    ds_write_b128 v249, a[128:131] offset:8192
    ds_write_b128 v249, a[132:135] offset:9216
    ds_write_b128 v249, a[136:139] offset:10240
    ds_write_b128 v249, a[140:143] offset:11264
L_SKIPW0:
    s_cmp_eq_u32 s30, 1
    s_cbranch_scc1 L_SKIPW1
    s_sub_u32 s54, 4, s30
    s_and_b32 s54, s54, 3
    s_mul_i32 s54, s54, 12288
    s_add_u32 s54, s54, s31
    v_add_u32 v249, s54, v248
    ds_write_b128 v249, a[16:19] offset:0
    ds_write_b128 v249, a[20:23] offset:1024
    ds_write_b128 v249, a[24:27] offset:2048
    ds_write_b128 v249, a[28:31] offset:3072
    ds_write_b128 v249, a[80:83] offset:4096
    ds_write_b128 v249, a[84:87] offset:5120
    ds_write_b128 v249, a[88:91] offset:6144
    ds_write_b128 v249, a[92:95] offset:7168
    ds_write_b128 v249, a[144:147] offset:8192
    ds_write_b128 v249, a[148:151] offset:9216
    ds_write_b128 v249, a[152:155] offset:10240
    ds_write_b128 v249, a[156:159] offset:11264
L_SKIPW1:
    s_cmp_eq_u32 s30, 2
    s_cbranch_scc1 L_SKIPW2
    s_sub_u32 s54, 5, s30
    s_and_b32 s54, s54, 3
    s_mul_i32 s54, s54, 12288
    s_add_u32 s54, s54, s31
    v_add_u32 v249, s54, v248
    ds_write_b128 v249, a[32:35] offset:0
    ds_write_b128 v249, a[36:39] offset:1024
    ds_write_b128 v249, a[40:43] offset:2048
    ds_write_b128 v249, a[44:47] offset:3072
    ds_write_b128 v249, a[96:99] offset:4096
    ds_write_b128 v249, a[100:103] offset:5120
    ds_write_b128 v249, a[104:107] offset:6144
    ds_write_b128 v249, a[108:111] offset:7168
    ds_write_b128 v249, a[160:163] offset:8192
    ds_write_b128 v249, a[164:167] offset:9216
    ds_write_b128 v249, a[168:171] offset:10240
    ds_write_b128 v249, a[172:175] offset:11264
L_SKIPW2:
    s_cmp_eq_u32 s30, 3
    s_cbranch_scc1 L_SKIPW3
    s_sub_u32 s54, 6, s30
    s_and_b32 s54, s54, 3
    s_mul_i32 s54, s54, 12288
    s_add_u32 s54, s54, s31
    v_add_u32 v249, s54, v248
    ds_write_b128 v249, a[48:51] offset:0
    ds_write_b128 v249, a[52:55] offset:1024
    ds_write_b128 v249, a[56:59] offset:2048
    ds_write_b128 v249, a[60:63] offset:3072
    ds_write_b128 v249, a[112:115] offset:4096
    ds_write_b128 v249, a[116:119] offset:5120
    ds_write_b128 v249, a[120:123] offset:6144
    ds_write_b128 v249, a[124:127] offset:7168
    ds_write_b128 v249, a[176:179] offset:8192
    ds_write_b128 v249, a[180:183] offset:9216
    ds_write_b128 v249, a[184:187] offset:10240
    ds_write_b128 v249, a[188:191] offset:11264
L_SKIPW3:
L_OWN0:
    s_cmp_lg_u32 s30, 0
    s_cbranch_scc1 L_OWN1
    v_accvgpr_read_b32 v48, a0
    v_accvgpr_read_b32 v49, a1
    v_accvgpr_read_b32 v50, a2
    v_accvgpr_read_b32 v51, a3
    v_accvgpr_read_b32 v52, a4
    v_accvgpr_read_b32 v53, a5
    v_accvgpr_read_b32 v54, a6
    v_accvgpr_read_b32 v55, a7
    v_accvgpr_read_b32 v56, a8
    v_accvgpr_read_b32 v57, a9
    v_accvgpr_read_b32 v58, a10
    v_accvgpr_read_b32 v59, a11
    v_accvgpr_read_b32 v60, a12
    v_accvgpr_read_b32 v61, a13
    v_accvgpr_read_b32 v62, a14
    v_accvgpr_read_b32 v63, a15
    v_accvgpr_read_b32 v64, a64
    v_accvgpr_read_b32 v65, a65
    v_accvgpr_read_b32 v66, a66
    v_accvgpr_read_b32 v67, a67
    v_accvgpr_read_b32 v68, a68
    v_accvgpr_read_b32 v69, a69
    v_accvgpr_read_b32 v70, a70
    v_accvgpr_read_b32 v71, a71
    v_accvgpr_read_b32 v72, a72
    v_accvgpr_read_b32 v73, a73
    v_accvgpr_read_b32 v74, a74
    v_accvgpr_read_b32 v75, a75
    v_accvgpr_read_b32 v76, a76
    v_accvgpr_read_b32 v77, a77
    v_accvgpr_read_b32 v78, a78
    v_accvgpr_read_b32 v79, a79
    v_accvgpr_read_b32 v80, a128
    v_accvgpr_read_b32 v81, a129
    v_accvgpr_read_b32 v82, a130
    v_accvgpr_read_b32 v83, a131
    v_accvgpr_read_b32 v84, a132
    v_accvgpr_read_b32 v85, a133
    v_accvgpr_read_b32 v86, a134
    v_accvgpr_read_b32 v87, a135
    v_accvgpr_read_b32 v88, a136
    v_accvgpr_read_b32 v89, a137
    v_accvgpr_read_b32 v90, a138
    v_accvgpr_read_b32 v91, a139
    v_accvgpr_read_b32 v92, a140
    v_accvgpr_read_b32 v93, a141
    v_accvgpr_read_b32 v94, a142
    v_accvgpr_read_b32 v95, a143
    s_branch L_OWNDONE
L_OWN1:
    s_cmp_lg_u32 s30, 1
    s_cbranch_scc1 L_OWN2
    v_accvgpr_read_b32 v48, a16
    v_accvgpr_read_b32 v49, a17
    v_accvgpr_read_b32 v50, a18
    v_accvgpr_read_b32 v51, a19
    v_accvgpr_read_b32 v52, a20
    v_accvgpr_read_b32 v53, a21
    v_accvgpr_read_b32 v54, a22
    v_accvgpr_read_b32 v55, a23
    v_accvgpr_read_b32 v56, a24
    v_accvgpr_read_b32 v57, a25
    v_accvgpr_read_b32 v58, a26
    v_accvgpr_read_b32 v59, a27
    v_accvgpr_read_b32 v60, a28
    v_accvgpr_read_b32 v61, a29
    v_accvgpr_read_b32 v62, a30
    v_accvgpr_read_b32 v63, a31
    v_accvgpr_read_b32 v64, a80
    v_accvgpr_read_b32 v65, a81
    v_accvgpr_read_b32 v66, a82
    v_accvgpr_read_b32 v67, a83
    v_accvgpr_read_b32 v68, a84
    v_accvgpr_read_b32 v69, a85
    v_accvgpr_read_b32 v70, a86
    v_accvgpr_read_b32 v71, a87
    v_accvgpr_read_b32 v72, a88
    v_accvgpr_read_b32 v73, a89
    v_accvgpr_read_b32 v74, a90
    v_accvgpr_read_b32 v75, a91
    v_accvgpr_read_b32 v76, a92
    v_accvgpr_read_b32 v77, a93
    v_accvgpr_read_b32 v78, a94
    v_accvgpr_read_b32 v79, a95
    v_accvgpr_read_b32 v80, a144
    v_accvgpr_read_b32 v81, a145
    v_accvgpr_read_b32 v82, a146
    v_accvgpr_read_b32 v83, a147
    v_accvgpr_read_b32 v84, a148
    v_accvgpr_read_b32 v85, a149
    v_accvgpr_read_b32 v86, a150
    v_accvgpr_read_b32 v87, a151
    v_accvgpr_read_b32 v88, a152
    v_accvgpr_read_b32 v89, a153
    v_accvgpr_read_b32 v90, a154
    v_accvgpr_read_b32 v91, a155
    v_accvgpr_read_b32 v92, a156
    v_accvgpr_read_b32 v93, a157
    v_accvgpr_read_b32 v94, a158
    v_accvgpr_read_b32 v95, a159
    s_branch L_OWNDONE
L_OWN2:
    s_cmp_lg_u32 s30, 2
    s_cbranch_scc1 L_OWN3
    v_accvgpr_read_b32 v48, a32
    v_accvgpr_read_b32 v49, a33
    v_accvgpr_read_b32 v50, a34
    v_accvgpr_read_b32 v51, a35
    v_accvgpr_read_b32 v52, a36
    v_accvgpr_read_b32 v53, a37
    v_accvgpr_read_b32 v54, a38
    v_accvgpr_read_b32 v55, a39
    v_accvgpr_read_b32 v56, a40
    v_accvgpr_read_b32 v57, a41
    v_accvgpr_read_b32 v58, a42
    v_accvgpr_read_b32 v59, a43
    v_accvgpr_read_b32 v60, a44
    v_accvgpr_read_b32 v61, a45
    v_accvgpr_read_b32 v62, a46
    v_accvgpr_read_b32 v63, a47
    v_accvgpr_read_b32 v64, a96
    v_accvgpr_read_b32 v65, a97
    v_accvgpr_read_b32 v66, a98
    v_accvgpr_read_b32 v67, a99
    v_accvgpr_read_b32 v68, a100
    v_accvgpr_read_b32 v69, a101
    v_accvgpr_read_b32 v70, a102
    v_accvgpr_read_b32 v71, a103
    v_accvgpr_read_b32 v72, a104
    v_accvgpr_read_b32 v73, a105
    v_accvgpr_read_b32 v74, a106
    v_accvgpr_read_b32 v75, a107
    v_accvgpr_read_b32 v76, a108
    v_accvgpr_read_b32 v77, a109
    v_accvgpr_read_b32 v78, a110
    v_accvgpr_read_b32 v79, a111
    v_accvgpr_read_b32 v80, a160
    v_accvgpr_read_b32 v81, a161
    v_accvgpr_read_b32 v82, a162
    v_accvgpr_read_b32 v83, a163
    v_accvgpr_read_b32 v84, a164
    v_accvgpr_read_b32 v85, a165
    v_accvgpr_read_b32 v86, a166
    v_accvgpr_read_b32 v87, a167
    v_accvgpr_read_b32 v88, a168
    v_accvgpr_read_b32 v89, a169
    v_accvgpr_read_b32 v90, a170
    v_accvgpr_read_b32 v91, a171
    v_accvgpr_read_b32 v92, a172
    v_accvgpr_read_b32 v93, a173
    v_accvgpr_read_b32 v94, a174
    v_accvgpr_read_b32 v95, a175
    s_branch L_OWNDONE
L_OWN3:
    v_accvgpr_read_b32 v48, a48
    v_accvgpr_read_b32 v49, a49
    v_accvgpr_read_b32 v50, a50
    v_accvgpr_read_b32 v51, a51
    v_accvgpr_read_b32 v52, a52
    v_accvgpr_read_b32 v53, a53
    v_accvgpr_read_b32 v54, a54
    v_accvgpr_read_b32 v55, a55
    v_accvgpr_read_b32 v56, a56
    v_accvgpr_read_b32 v57, a57
    v_accvgpr_read_b32 v58, a58
    v_accvgpr_read_b32 v59, a59
    v_accvgpr_read_b32 v60, a60
    v_accvgpr_read_b32 v61, a61
    v_accvgpr_read_b32 v62, a62
    v_accvgpr_read_b32 v63, a63
    v_accvgpr_read_b32 v64, a112
    v_accvgpr_read_b32 v65, a113
    v_accvgpr_read_b32 v66, a114
    v_accvgpr_read_b32 v67, a115
    v_accvgpr_read_b32 v68, a116
    v_accvgpr_read_b32 v69, a117
    v_accvgpr_read_b32 v70, a118
    v_accvgpr_read_b32 v71, a119
    v_accvgpr_read_b32 v72, a120
    v_accvgpr_read_b32 v73, a121
    v_accvgpr_read_b32 v74, a122
    v_accvgpr_read_b32 v75, a123
    v_accvgpr_read_b32 v76, a124
    v_accvgpr_read_b32 v77, a125
    v_accvgpr_read_b32 v78, a126
    v_accvgpr_read_b32 v79, a127
    v_accvgpr_read_b32 v80, a176
    v_accvgpr_read_b32 v81, a177
    v_accvgpr_read_b32 v82, a178
    v_accvgpr_read_b32 v83, a179
    v_accvgpr_read_b32 v84, a180
    v_accvgpr_read_b32 v85, a181
    v_accvgpr_read_b32 v86, a182
    v_accvgpr_read_b32 v87, a183
    v_accvgpr_read_b32 v88, a184
    v_accvgpr_read_b32 v89, a185
    v_accvgpr_read_b32 v90, a186
    v_accvgpr_read_b32 v91, a187
    v_accvgpr_read_b32 v92, a188
    v_accvgpr_read_b32 v93, a189
    v_accvgpr_read_b32 v94, a190
    v_accvgpr_read_b32 v95, a191
L_OWNDONE:
    v_and_b32 v243, 31, v1
    v_lshrrev_b32 v239, 5, v1
    v_lshlrev_b32 v243, 8, v243
    v_lshl_add_u32 v243, v239, 3, v243
    s_lshl_b32 s54, s30, 6
    v_add_u32 v243, s54, v243
    s_waitcnt lgkmcnt(0)
    s_barrier
    ds_read_b32 v200, v244 offset:38912
    ds_read_b32 v216, v244 offset:39680
    ds_read_b32 v201, v244 offset:39168
    ds_read_b32 v217, v244 offset:39936
    ds_read_b32 v202, v244 offset:39424
    ds_read_b32 v218, v244 offset:40192
    ds_read_b32 v204, v245 offset:38912
    ds_read_b32 v220, v245 offset:39680
    ds_read_b32 v205, v245 offset:39168
    ds_read_b32 v221, v245 offset:39936
    ds_read_b32 v206, v245 offset:39424
    ds_read_b32 v222, v245 offset:40192
    ds_read_b32 v208, v246 offset:38912
    ds_read_b32 v224, v246 offset:39680
    ds_read_b32 v209, v246 offset:39168
    ds_read_b32 v225, v246 offset:39936
    ds_read_b32 v210, v246 offset:39424
    ds_read_b32 v226, v246 offset:40192
    ds_read_b32 v212, v247 offset:38912
    ds_read_b32 v228, v247 offset:39680
    ds_read_b32 v213, v247 offset:39168
    ds_read_b32 v229, v247 offset:39936
    ds_read_b32 v214, v247 offset:39424
    ds_read_b32 v230, v247 offset:40192
    s_cmp_eq_u32 s30, 0
    s_cbranch_scc1 L_SKIPR0
    s_add_u32 s54, s30, 7
    s_and_b32 s54, s54, 3
    s_mul_i32 s54, s54, 12288
    s_add_u32 s54, s54, 0
    v_add_u32 v249, s54, v248
    ds_read_b128 v[96:99], v249 offset:0
    ds_read_b128 v[100:103], v249 offset:1024
    ds_read_b128 v[104:107], v249 offset:2048
    ds_read_b128 v[108:111], v249 offset:3072
    ds_read_b128 v[112:115], v249 offset:4096
    ds_read_b128 v[116:119], v249 offset:5120
    ds_read_b128 v[120:123], v249 offset:6144
    ds_read_b128 v[124:127], v249 offset:7168
    ds_read_b128 v[128:131], v249 offset:8192
    ds_read_b128 v[132:135], v249 offset:9216
    ds_read_b128 v[136:139], v249 offset:10240
    ds_read_b128 v[140:143], v249 offset:11264
L_SKIPR0:
    s_cmp_eq_u32 s30, 1
    s_cbranch_scc1 L_SKIPR1
    s_add_u32 s54, s30, 6
    s_and_b32 s54, s54, 3
    s_mul_i32 s54, s54, 12288
    s_add_u32 s54, s54, 40960
    v_add_u32 v249, s54, v248
    ds_read_b128 v[144:147], v249 offset:0
    ds_read_b128 v[148:151], v249 offset:1024
    ds_read_b128 v[152:155], v249 offset:2048
    ds_read_b128 v[156:159], v249 offset:3072
    ds_read_b128 v[160:163], v249 offset:4096
    ds_read_b128 v[164:167], v249 offset:5120
    ds_read_b128 v[168:171], v249 offset:6144
    ds_read_b128 v[172:175], v249 offset:7168
    ds_read_b128 v[176:179], v249 offset:8192
    ds_read_b128 v[180:183], v249 offset:9216
    ds_read_b128 v[184:187], v249 offset:10240
    ds_read_b128 v[188:191], v249 offset:11264
L_SKIPR1:
    s_waitcnt lgkmcnt(0)
    v_max_f32 v232, v200, v204
    v_max3_f32 v232, v232, v208, v212
    v_sub_f32 v200, v200, v232
    v_exp_f32 v200, v200
    v_sub_f32 v204, v204, v232
    v_exp_f32 v204, v204
    v_sub_f32 v208, v208, v232
    v_exp_f32 v208, v208
    v_sub_f32 v212, v212, v232
    v_exp_f32 v212, v212
    s_nop 0
    v_mul_f32 v236, v200, v216
    v_fmac_f32 v236, v204, v220
    v_fmac_f32 v236, v208, v224
    v_fmac_f32 v236, v212, v228
    v_rcp_f32 v236, v236
    v_sub_f32 v240, v10, v232
    v_exp_f32 v240, v240
    s_nop 0
    v_mul_f32 v240, v240, v236
    v_mul_f32 v200, v200, v236
    v_mul_f32 v204, v204, v236
    v_mul_f32 v208, v208, v236
    v_mul_f32 v212, v212, v236
    v_max_f32 v233, v201, v205
    v_max3_f32 v233, v233, v209, v213
    v_sub_f32 v201, v201, v233
    v_exp_f32 v201, v201
    v_sub_f32 v205, v205, v233
    v_exp_f32 v205, v205
    v_sub_f32 v209, v209, v233
    v_exp_f32 v209, v209
    v_sub_f32 v213, v213, v233
    v_exp_f32 v213, v213
    s_nop 0
    v_mul_f32 v237, v201, v217
    v_fmac_f32 v237, v205, v221
    v_fmac_f32 v237, v209, v225
    v_fmac_f32 v237, v213, v229
    v_rcp_f32 v237, v237
    v_sub_f32 v241, v11, v233
    v_exp_f32 v241, v241
    s_nop 0
    v_mul_f32 v241, v241, v237
    v_mul_f32 v201, v201, v237
    v_mul_f32 v205, v205, v237
    v_mul_f32 v209, v209, v237
    v_mul_f32 v213, v213, v237
    v_max_f32 v234, v202, v206
    v_max3_f32 v234, v234, v210, v214
    v_sub_f32 v202, v202, v234
    v_exp_f32 v202, v202
    v_sub_f32 v206, v206, v234
    v_exp_f32 v206, v206
    v_sub_f32 v210, v210, v234
    v_exp_f32 v210, v210
    v_sub_f32 v214, v214, v234
    v_exp_f32 v214, v214
    s_nop 0
    v_mul_f32 v238, v202, v218
    v_fmac_f32 v238, v206, v222
    v_fmac_f32 v238, v210, v226
    v_fmac_f32 v238, v214, v230
    v_rcp_f32 v238, v238
    v_sub_f32 v242, v12, v234
    v_exp_f32 v242, v242
    s_nop 0
    v_mul_f32 v242, v242, v238
    v_mul_f32 v202, v202, v238
    v_mul_f32 v206, v206, v238
    v_mul_f32 v210, v210, v238
    v_mul_f32 v214, v214, v238
    v_mul_f32 v48, v48, v240
    v_mul_f32 v49, v49, v240
    v_mul_f32 v50, v50, v240
    v_mul_f32 v51, v51, v240
    v_mul_f32 v52, v52, v240
    v_mul_f32 v53, v53, v240
    v_mul_f32 v54, v54, v240
    v_mul_f32 v55, v55, v240
    v_mul_f32 v56, v56, v240
    v_mul_f32 v57, v57, v240
    v_mul_f32 v58, v58, v240
    v_mul_f32 v59, v59, v240
    v_mul_f32 v60, v60, v240
    v_mul_f32 v61, v61, v240
    v_mul_f32 v62, v62, v240
    v_mul_f32 v63, v63, v240
    v_mul_f32 v64, v64, v241
    v_mul_f32 v65, v65, v241
    v_mul_f32 v66, v66, v241
    v_mul_f32 v67, v67, v241
    v_mul_f32 v68, v68, v241
    v_mul_f32 v69, v69, v241
    v_mul_f32 v70, v70, v241
    v_mul_f32 v71, v71, v241
    v_mul_f32 v72, v72, v241
    v_mul_f32 v73, v73, v241
    v_mul_f32 v74, v74, v241
    v_mul_f32 v75, v75, v241
    v_mul_f32 v76, v76, v241
    v_mul_f32 v77, v77, v241
    v_mul_f32 v78, v78, v241
    v_mul_f32 v79, v79, v241
    v_mul_f32 v80, v80, v242
    v_mul_f32 v81, v81, v242
    v_mul_f32 v82, v82, v242
    v_mul_f32 v83, v83, v242
    v_mul_f32 v84, v84, v242
    v_mul_f32 v85, v85, v242
    v_mul_f32 v86, v86, v242
    v_mul_f32 v87, v87, v242
    v_mul_f32 v88, v88, v242
    v_mul_f32 v89, v89, v242
    v_mul_f32 v90, v90, v242
    v_mul_f32 v91, v91, v242
    v_mul_f32 v92, v92, v242
    v_mul_f32 v93, v93, v242
    v_mul_f32 v94, v94, v242
    v_mul_f32 v95, v95, v242
    s_cmp_eq_u32 s30, 0
    s_cbranch_scc1 L_SKIPA0
    v_fmac_f32 v48, v96, v200
    v_fmac_f32 v49, v97, v200
    v_fmac_f32 v50, v98, v200
    v_fmac_f32 v51, v99, v200
    v_fmac_f32 v52, v100, v200
    v_fmac_f32 v53, v101, v200
    v_fmac_f32 v54, v102, v200
    v_fmac_f32 v55, v103, v200
    v_fmac_f32 v56, v104, v200
    v_fmac_f32 v57, v105, v200
    v_fmac_f32 v58, v106, v200
    v_fmac_f32 v59, v107, v200
    v_fmac_f32 v60, v108, v200
    v_fmac_f32 v61, v109, v200
    v_fmac_f32 v62, v110, v200
    v_fmac_f32 v63, v111, v200
    v_fmac_f32 v64, v112, v201
    v_fmac_f32 v65, v113, v201
    v_fmac_f32 v66, v114, v201
    v_fmac_f32 v67, v115, v201
    v_fmac_f32 v68, v116, v201
    v_fmac_f32 v69, v117, v201
    v_fmac_f32 v70, v118, v201
    v_fmac_f32 v71, v119, v201
    v_fmac_f32 v72, v120, v201
    v_fmac_f32 v73, v121, v201
    v_fmac_f32 v74, v122, v201
    v_fmac_f32 v75, v123, v201
    v_fmac_f32 v76, v124, v201
    v_fmac_f32 v77, v125, v201
    v_fmac_f32 v78, v126, v201
    v_fmac_f32 v79, v127, v201
    v_fmac_f32 v80, v128, v202
    v_fmac_f32 v81, v129, v202
    v_fmac_f32 v82, v130, v202
    v_fmac_f32 v83, v131, v202
    v_fmac_f32 v84, v132, v202
    v_fmac_f32 v85, v133, v202
    v_fmac_f32 v86, v134, v202
    v_fmac_f32 v87, v135, v202
    v_fmac_f32 v88, v136, v202
    v_fmac_f32 v89, v137, v202
    v_fmac_f32 v90, v138, v202
    v_fmac_f32 v91, v139, v202
    v_fmac_f32 v92, v140, v202
    v_fmac_f32 v93, v141, v202
    v_fmac_f32 v94, v142, v202
    v_fmac_f32 v95, v143, v202
L_SKIPA0:
    s_cmp_eq_u32 s30, 2
    s_cbranch_scc1 L_SKIPR2
    s_add_u32 s54, s30, 5
    s_and_b32 s54, s54, 3
    s_mul_i32 s54, s54, 12288
    s_add_u32 s54, s54, 81920
    v_add_u32 v249, s54, v248
    ds_read_b128 v[96:99], v249 offset:0
    ds_read_b128 v[100:103], v249 offset:1024
    ds_read_b128 v[104:107], v249 offset:2048
    ds_read_b128 v[108:111], v249 offset:3072
    ds_read_b128 v[112:115], v249 offset:4096
    ds_read_b128 v[116:119], v249 offset:5120
    ds_read_b128 v[120:123], v249 offset:6144
    ds_read_b128 v[124:127], v249 offset:7168
    ds_read_b128 v[128:131], v249 offset:8192
    ds_read_b128 v[132:135], v249 offset:9216
    ds_read_b128 v[136:139], v249 offset:10240
    ds_read_b128 v[140:143], v249 offset:11264
L_SKIPR2:
    s_cmp_eq_u32 s30, 1
    s_cbranch_scc1 L_SKIPA1
    v_fmac_f32 v48, v144, v204
    v_fmac_f32 v49, v145, v204
    v_fmac_f32 v50, v146, v204
    v_fmac_f32 v51, v147, v204
    v_fmac_f32 v52, v148, v204
    v_fmac_f32 v53, v149, v204
    v_fmac_f32 v54, v150, v204
    v_fmac_f32 v55, v151, v204
    v_fmac_f32 v56, v152, v204
    v_fmac_f32 v57, v153, v204
    v_fmac_f32 v58, v154, v204
    v_fmac_f32 v59, v155, v204
    v_fmac_f32 v60, v156, v204
    v_fmac_f32 v61, v157, v204
    v_fmac_f32 v62, v158, v204
    v_fmac_f32 v63, v159, v204
    v_fmac_f32 v64, v160, v205
    v_fmac_f32 v65, v161, v205
    v_fmac_f32 v66, v162, v205
    v_fmac_f32 v67, v163, v205
    v_fmac_f32 v68, v164, v205
    v_fmac_f32 v69, v165, v205
    v_fmac_f32 v70, v166, v205
    v_fmac_f32 v71, v167, v205
    v_fmac_f32 v72, v168, v205
    v_fmac_f32 v73, v169, v205
    v_fmac_f32 v74, v170, v205
    v_fmac_f32 v75, v171, v205
    v_fmac_f32 v76, v172, v205
    v_fmac_f32 v77, v173, v205
    v_fmac_f32 v78, v174, v205
    v_fmac_f32 v79, v175, v205
    v_fmac_f32 v80, v176, v206
    v_fmac_f32 v81, v177, v206
    v_fmac_f32 v82, v178, v206
    v_fmac_f32 v83, v179, v206
    v_fmac_f32 v84, v180, v206
    v_fmac_f32 v85, v181, v206
    v_fmac_f32 v86, v182, v206
    v_fmac_f32 v87, v183, v206
    v_fmac_f32 v88, v184, v206
    v_fmac_f32 v89, v185, v206
    v_fmac_f32 v90, v186, v206
    v_fmac_f32 v91, v187, v206
    v_fmac_f32 v92, v188, v206
    v_fmac_f32 v93, v189, v206
    v_fmac_f32 v94, v190, v206
    v_fmac_f32 v95, v191, v206
L_SKIPA1:
    s_cmp_eq_u32 s30, 3
    s_cbranch_scc1 L_SKIPR3
    s_add_u32 s54, s30, 4
    s_and_b32 s54, s54, 3
    s_mul_i32 s54, s54, 12288
    s_add_u32 s54, s54, 122880
    v_add_u32 v249, s54, v248
    ds_read_b128 v[144:147], v249 offset:0
    ds_read_b128 v[148:151], v249 offset:1024
    ds_read_b128 v[152:155], v249 offset:2048
    ds_read_b128 v[156:159], v249 offset:3072
    ds_read_b128 v[160:163], v249 offset:4096
    ds_read_b128 v[164:167], v249 offset:5120
    ds_read_b128 v[168:171], v249 offset:6144
    ds_read_b128 v[172:175], v249 offset:7168
    ds_read_b128 v[176:179], v249 offset:8192
    ds_read_b128 v[180:183], v249 offset:9216
    ds_read_b128 v[184:187], v249 offset:10240
    ds_read_b128 v[188:191], v249 offset:11264
L_SKIPR3:
    s_waitcnt lgkmcnt(0)
    s_cmp_eq_u32 s30, 2
    s_cbranch_scc1 L_SKIPA2
    v_fmac_f32 v48, v96, v208
    v_fmac_f32 v49, v97, v208
    v_fmac_f32 v50, v98, v208
    v_fmac_f32 v51, v99, v208
    v_fmac_f32 v52, v100, v208
    v_fmac_f32 v53, v101, v208
    v_fmac_f32 v54, v102, v208
    v_fmac_f32 v55, v103, v208
    v_fmac_f32 v56, v104, v208
    v_fmac_f32 v57, v105, v208
    v_fmac_f32 v58, v106, v208
    v_fmac_f32 v59, v107, v208
    v_fmac_f32 v60, v108, v208
    v_fmac_f32 v61, v109, v208
    v_fmac_f32 v62, v110, v208
    v_fmac_f32 v63, v111, v208
    v_fmac_f32 v64, v112, v209
    v_fmac_f32 v65, v113, v209
    v_fmac_f32 v66, v114, v209
    v_fmac_f32 v67, v115, v209
    v_fmac_f32 v68, v116, v209
    v_fmac_f32 v69, v117, v209
    v_fmac_f32 v70, v118, v209
    v_fmac_f32 v71, v119, v209
    v_fmac_f32 v72, v120, v209
    v_fmac_f32 v73, v121, v209
    v_fmac_f32 v74, v122, v209
    v_fmac_f32 v75, v123, v209
    v_fmac_f32 v76, v124, v209
    v_fmac_f32 v77, v125, v209
    v_fmac_f32 v78, v126, v209
    v_fmac_f32 v79, v127, v209
    v_fmac_f32 v80, v128, v210
    v_fmac_f32 v81, v129, v210
    v_fmac_f32 v82, v130, v210
    v_fmac_f32 v83, v131, v210
    v_fmac_f32 v84, v132, v210
    v_fmac_f32 v85, v133, v210
    v_fmac_f32 v86, v134, v210
    v_fmac_f32 v87, v135, v210
    v_fmac_f32 v88, v136, v210
    v_fmac_f32 v89, v137, v210
    v_fmac_f32 v90, v138, v210
    v_fmac_f32 v91, v139, v210
    v_fmac_f32 v92, v140, v210
    v_fmac_f32 v93, v141, v210
    v_fmac_f32 v94, v142, v210
    v_fmac_f32 v95, v143, v210
L_SKIPA2:
    s_cmp_eq_u32 s30, 3
    s_cbranch_scc1 L_SKIPA3
    v_fmac_f32 v48, v144, v212
    v_fmac_f32 v49, v145, v212
    v_fmac_f32 v50, v146, v212
    v_fmac_f32 v51, v147, v212
    v_fmac_f32 v52, v148, v212
    v_fmac_f32 v53, v149, v212
    v_fmac_f32 v54, v150, v212
    v_fmac_f32 v55, v151, v212
    v_fmac_f32 v56, v152, v212
    v_fmac_f32 v57, v153, v212
    v_fmac_f32 v58, v154, v212
    v_fmac_f32 v59, v155, v212
    v_fmac_f32 v60, v156, v212
    v_fmac_f32 v61, v157, v212
    v_fmac_f32 v62, v158, v212
    v_fmac_f32 v63, v159, v212
    v_fmac_f32 v64, v160, v213
    v_fmac_f32 v65, v161, v213
    v_fmac_f32 v66, v162, v213
    v_fmac_f32 v67, v163, v213
    v_fmac_f32 v68, v164, v213
    v_fmac_f32 v69, v165, v213
    v_fmac_f32 v70, v166, v213
    v_fmac_f32 v71, v167, v213
    v_fmac_f32 v72, v168, v213
    v_fmac_f32 v73, v169, v213
    v_fmac_f32 v74, v170, v213
    v_fmac_f32 v75, v171, v213
    v_fmac_f32 v76, v172, v213
    v_fmac_f32 v77, v173, v213
    v_fmac_f32 v78, v174, v213
    v_fmac_f32 v79, v175, v213
    v_fmac_f32 v80, v176, v214
    v_fmac_f32 v81, v177, v214
    v_fmac_f32 v82, v178, v214
    v_fmac_f32 v83, v179, v214
    v_fmac_f32 v84, v180, v214
    v_fmac_f32 v85, v181, v214
    v_fmac_f32 v86, v182, v214
    v_fmac_f32 v87, v183, v214
    v_fmac_f32 v88, v184, v214
    v_fmac_f32 v89, v185, v214
    v_fmac_f32 v90, v186, v214
    v_fmac_f32 v91, v187, v214
    v_fmac_f32 v92, v188, v214
    v_fmac_f32 v93, v189, v214
    v_fmac_f32 v94, v190, v214
    v_fmac_f32 v95, v191, v214
L_SKIPA3:
    s_add_u32 s55, s41, 4096
    v_and_b32 v243, 31, v1
    v_lshrrev_b32 v239, 5, v1
    v_mul_u32_u24 v243, 272, v243
    v_lshl_add_u32 v243, v239, 3, v243
    s_lshl_b32 s54, s30, 6
    v_add_u32 v243, s54, v243
    v_cvt_pk_bf16_f32 v48, v48, v49
    v_cvt_pk_bf16_f32 v49, v50, v51
    v_cvt_pk_bf16_f32 v52, v52, v53
    v_cvt_pk_bf16_f32 v53, v54, v55
    v_cvt_pk_bf16_f32 v56, v56, v57
    v_cvt_pk_bf16_f32 v57, v58, v59
    v_cvt_pk_bf16_f32 v60, v60, v61
    v_cvt_pk_bf16_f32 v61, v62, v63
    v_cvt_pk_bf16_f32 v64, v64, v65
    v_cvt_pk_bf16_f32 v65, v66, v67
    v_cvt_pk_bf16_f32 v68, v68, v69
    v_cvt_pk_bf16_f32 v69, v70, v71
    v_cvt_pk_bf16_f32 v72, v72, v73
    v_cvt_pk_bf16_f32 v73, v74, v75
    v_cvt_pk_bf16_f32 v76, v76, v77
    v_cvt_pk_bf16_f32 v77, v78, v79
    v_cvt_pk_bf16_f32 v80, v80, v81
    v_cvt_pk_bf16_f32 v81, v82, v83
    v_cvt_pk_bf16_f32 v84, v84, v85
    v_cvt_pk_bf16_f32 v85, v86, v87
    v_cvt_pk_bf16_f32 v88, v88, v89
    v_cvt_pk_bf16_f32 v89, v90, v91
    v_cvt_pk_bf16_f32 v92, v92, v93
    v_cvt_pk_bf16_f32 v93, v94, v95
    s_barrier
    ds_write_b64 v243, v[48:49] offset:0
    ds_write_b64 v243, v[52:53] offset:16
    ds_write_b64 v243, v[56:57] offset:32
    ds_write_b64 v243, v[60:61] offset:48
    ds_write_b64 v243, v[64:65] offset:8704
    ds_write_b64 v243, v[68:69] offset:8720
    ds_write_b64 v243, v[72:73] offset:8736
    ds_write_b64 v243, v[76:77] offset:8752
    ds_write_b64 v243, v[80:81] offset:17408
    ds_write_b64 v243, v[84:85] offset:17424
    ds_write_b64 v243, v[88:89] offset:17440
    ds_write_b64 v243, v[92:93] offset:17456
    v_lshrrev_b32 v239, 4, v1
    s_mul_i32 s54, s30, 24
    v_add_u32 v239, s54, v239
    v_and_b32 v242, 15, v1
    v_lshlrev_b32 v242, 4, v242
    v_mul_u32_u24 v241, 272, v239
    v_add_u32 v241, v241, v242
    v_lshl_add_u32 v240, v239, 8, v242
    s_waitcnt lgkmcnt(0)
    s_barrier
    ds_read_b128 v[96:99], v241 offset:0
    ds_read_b128 v[100:103], v241 offset:1088
    ds_read_b128 v[104:107], v241 offset:2176
    ds_read_b128 v[108:111], v241 offset:3264
    ds_read_b128 v[112:115], v241 offset:4352
    ds_read_b128 v[116:119], v241 offset:5440
    s_waitcnt lgkmcnt(5)
    buffer_store_dwordx4 v[96:99], v240, s[24:27], s41 offen offset:0
    s_waitcnt lgkmcnt(4)
    buffer_store_dwordx4 v[100:103], v240, s[24:27], s41 offen offset:1024
    s_waitcnt lgkmcnt(3)
    buffer_store_dwordx4 v[104:107], v240, s[24:27], s41 offen offset:2048
    s_waitcnt lgkmcnt(2)
    buffer_store_dwordx4 v[108:111], v240, s[24:27], s41 offen offset:3072
    s_waitcnt lgkmcnt(1)
    buffer_store_dwordx4 v[112:115], v240, s[24:27], s55 offen offset:0
    s_waitcnt lgkmcnt(0)
    buffer_store_dwordx4 v[116:119], v240, s[24:27], s55 offen offset:1024
L_END:
    s_endpgm
RESC_LA_0:
    v_max_f32 v197, v10, v196
    v_sub_f32 v199, v10, v197
    v_exp_f32 v199, v199
    v_mov_b32 v10, v197
    s_nop 0
    v_mul_f32 v13, v13, v199
    s_cmp_eq_u32 s38, 0
    s_cbranch_scc1 RET_LA_0
    v_accvgpr_read_b32 v197, a0
    v_accvgpr_read_b32 v198, a1
    s_nop 0
    v_mul_f32 v197, v197, v199
    v_mul_f32 v198, v198, v199
    v_accvgpr_write_b32 a0, v197
    v_accvgpr_write_b32 a1, v198
    v_accvgpr_read_b32 v197, a2
    v_accvgpr_read_b32 v198, a3
    s_nop 0
    v_mul_f32 v197, v197, v199
    v_mul_f32 v198, v198, v199
    v_accvgpr_write_b32 a2, v197
    v_accvgpr_write_b32 a3, v198
    v_accvgpr_read_b32 v197, a4
    v_accvgpr_read_b32 v198, a5
    s_nop 0
    v_mul_f32 v197, v197, v199
    v_mul_f32 v198, v198, v199
    v_accvgpr_write_b32 a4, v197
    v_accvgpr_write_b32 a5, v198
    v_accvgpr_read_b32 v197, a6
    v_accvgpr_read_b32 v198, a7
    s_nop 0
    v_mul_f32 v197, v197, v199
    v_mul_f32 v198, v198, v199
    v_accvgpr_write_b32 a6, v197
    v_accvgpr_write_b32 a7, v198
    v_accvgpr_read_b32 v197, a8
    v_accvgpr_read_b32 v198, a9
    s_nop 0
    v_mul_f32 v197, v197, v199
    v_mul_f32 v198, v198, v199
    v_accvgpr_write_b32 a8, v197
    v_accvgpr_write_b32 a9, v198
    v_accvgpr_read_b32 v197, a10
    v_accvgpr_read_b32 v198, a11
    s_nop 0
    v_mul_f32 v197, v197, v199
    v_mul_f32 v198, v198, v199
    v_accvgpr_write_b32 a10, v197
    v_accvgpr_write_b32 a11, v198
    v_accvgpr_read_b32 v197, a12
    v_accvgpr_read_b32 v198, a13
    s_nop 0
    v_mul_f32 v197, v197, v199
    v_mul_f32 v198, v198, v199
    v_accvgpr_write_b32 a12, v197
    v_accvgpr_write_b32 a13, v198
    v_accvgpr_read_b32 v197, a14
    v_accvgpr_read_b32 v198, a15
    s_nop 0
    v_mul_f32 v197, v197, v199
    v_mul_f32 v198, v198, v199
    v_accvgpr_write_b32 a14, v197
    v_accvgpr_write_b32 a15, v198
    v_accvgpr_read_b32 v197, a16
    v_accvgpr_read_b32 v198, a17
    s_nop 0
    v_mul_f32 v197, v197, v199
    v_mul_f32 v198, v198, v199
    v_accvgpr_write_b32 a16, v197
    v_accvgpr_write_b32 a17, v198
    v_accvgpr_read_b32 v197, a18
    v_accvgpr_read_b32 v198, a19
    s_nop 0
    v_mul_f32 v197, v197, v199
    v_mul_f32 v198, v198, v199
    v_accvgpr_write_b32 a18, v197
    v_accvgpr_write_b32 a19, v198
    v_accvgpr_read_b32 v197, a20
    v_accvgpr_read_b32 v198, a21
    s_nop 0
    v_mul_f32 v197, v197, v199
    v_mul_f32 v198, v198, v199
    v_accvgpr_write_b32 a20, v197
    v_accvgpr_write_b32 a21, v198
    v_accvgpr_read_b32 v197, a22
    v_accvgpr_read_b32 v198, a23
    s_nop 0
    v_mul_f32 v197, v197, v199
    v_mul_f32 v198, v198, v199
    v_accvgpr_write_b32 a22, v197
    v_accvgpr_write_b32 a23, v198
    v_accvgpr_read_b32 v197, a24
    v_accvgpr_read_b32 v198, a25
    s_nop 0
    v_mul_f32 v197, v197, v199
    v_mul_f32 v198, v198, v199
    v_accvgpr_write_b32 a24, v197
    v_accvgpr_write_b32 a25, v198
    v_accvgpr_read_b32 v197, a26
    v_accvgpr_read_b32 v198, a27
    s_nop 0
    v_mul_f32 v197, v197, v199
    v_mul_f32 v198, v198, v199
    v_accvgpr_write_b32 a26, v197
    v_accvgpr_write_b32 a27, v198
    v_accvgpr_read_b32 v197, a28
    v_accvgpr_read_b32 v198, a29
    s_nop 0
    v_mul_f32 v197, v197, v199
    v_mul_f32 v198, v198, v199
    v_accvgpr_write_b32 a28, v197
    v_accvgpr_write_b32 a29, v198
    v_accvgpr_read_b32 v197, a30
    v_accvgpr_read_b32 v198, a31
    s_nop 0
    v_mul_f32 v197, v197, v199
    v_mul_f32 v198, v198, v199
    v_accvgpr_write_b32 a30, v197
    v_accvgpr_write_b32 a31, v198
    v_accvgpr_read_b32 v197, a32
    v_accvgpr_read_b32 v198, a33
    s_nop 0
    v_mul_f32 v197, v197, v199
    v_mul_f32 v198, v198, v199
    v_accvgpr_write_b32 a32, v197
    v_accvgpr_write_b32 a33, v198
    v_accvgpr_read_b32 v197, a34
    v_accvgpr_read_b32 v198, a35
    s_nop 0
    v_mul_f32 v197, v197, v199
    v_mul_f32 v198, v198, v199
    v_accvgpr_write_b32 a34, v197
    v_accvgpr_write_b32 a35, v198
    v_accvgpr_read_b32 v197, a36
    v_accvgpr_read_b32 v198, a37
    s_nop 0
    v_mul_f32 v197, v197, v199
    v_mul_f32 v198, v198, v199
    v_accvgpr_write_b32 a36, v197
    v_accvgpr_write_b32 a37, v198
    v_accvgpr_read_b32 v197, a38
    v_accvgpr_read_b32 v198, a39
    s_nop 0
    v_mul_f32 v197, v197, v199
    v_mul_f32 v198, v198, v199
    v_accvgpr_write_b32 a38, v197
    v_accvgpr_write_b32 a39, v198
    v_accvgpr_read_b32 v197, a40
    v_accvgpr_read_b32 v198, a41
    s_nop 0
    v_mul_f32 v197, v197, v199
    v_mul_f32 v198, v198, v199
    v_accvgpr_write_b32 a40, v197
    v_accvgpr_write_b32 a41, v198
    v_accvgpr_read_b32 v197, a42
    v_accvgpr_read_b32 v198, a43
    s_nop 0
    v_mul_f32 v197, v197, v199
    v_mul_f32 v198, v198, v199
    v_accvgpr_write_b32 a42, v197
    v_accvgpr_write_b32 a43, v198
    v_accvgpr_read_b32 v197, a44
    v_accvgpr_read_b32 v198, a45
    s_nop 0
    v_mul_f32 v197, v197, v199
    v_mul_f32 v198, v198, v199
    v_accvgpr_write_b32 a44, v197
    v_accvgpr_write_b32 a45, v198
    v_accvgpr_read_b32 v197, a46
    v_accvgpr_read_b32 v198, a47
    s_nop 0
    v_mul_f32 v197, v197, v199
    v_mul_f32 v198, v198, v199
    v_accvgpr_write_b32 a46, v197
    v_accvgpr_write_b32 a47, v198
    v_accvgpr_read_b32 v197, a48
    v_accvgpr_read_b32 v198, a49
    s_nop 0
    v_mul_f32 v197, v197, v199
    v_mul_f32 v198, v198, v199
    v_accvgpr_write_b32 a48, v197
    v_accvgpr_write_b32 a49, v198
    v_accvgpr_read_b32 v197, a50
    v_accvgpr_read_b32 v198, a51
    s_nop 0
    v_mul_f32 v197, v197, v199
    v_mul_f32 v198, v198, v199
    v_accvgpr_write_b32 a50, v197
    v_accvgpr_write_b32 a51, v198
    v_accvgpr_read_b32 v197, a52
    v_accvgpr_read_b32 v198, a53
    s_nop 0
    v_mul_f32 v197, v197, v199
    v_mul_f32 v198, v198, v199
    v_accvgpr_write_b32 a52, v197
    v_accvgpr_write_b32 a53, v198
    v_accvgpr_read_b32 v197, a54
    v_accvgpr_read_b32 v198, a55
    s_nop 0
    v_mul_f32 v197, v197, v199
    v_mul_f32 v198, v198, v199
    v_accvgpr_write_b32 a54, v197
    v_accvgpr_write_b32 a55, v198
    v_accvgpr_read_b32 v197, a56
    v_accvgpr_read_b32 v198, a57
    s_nop 0
    v_mul_f32 v197, v197, v199
    v_mul_f32 v198, v198, v199
    v_accvgpr_write_b32 a56, v197
    v_accvgpr_write_b32 a57, v198
    v_accvgpr_read_b32 v197, a58
    v_accvgpr_read_b32 v198, a59
    s_nop 0
    v_mul_f32 v197, v197, v199
    v_mul_f32 v198, v198, v199
    v_accvgpr_write_b32 a58, v197
    v_accvgpr_write_b32 a59, v198
    v_accvgpr_read_b32 v197, a60
    v_accvgpr_read_b32 v198, a61
    s_nop 0
    v_mul_f32 v197, v197, v199
    v_mul_f32 v198, v198, v199
    v_accvgpr_write_b32 a60, v197
    v_accvgpr_write_b32 a61, v198
    v_accvgpr_read_b32 v197, a62
    v_accvgpr_read_b32 v198, a63
    s_nop 0
    v_mul_f32 v197, v197, v199
    v_mul_f32 v198, v198, v199
    v_accvgpr_write_b32 a62, v197
    v_accvgpr_write_b32 a63, v198
    s_nop 1
    s_branch RET_LA_0
RESC_LA_1:
    v_max_f32 v201, v11, v200
    v_sub_f32 v203, v11, v201
    v_exp_f32 v203, v203
    v_mov_b32 v11, v201
    s_nop 0
    v_mul_f32 v14, v14, v203
    s_cmp_eq_u32 s38, 0
    s_cbranch_scc1 RET_LA_1
    v_accvgpr_read_b32 v201, a64
    v_accvgpr_read_b32 v202, a65
    s_nop 0
    v_mul_f32 v201, v201, v203
    v_mul_f32 v202, v202, v203
    v_accvgpr_write_b32 a64, v201
    v_accvgpr_write_b32 a65, v202
    v_accvgpr_read_b32 v201, a66
    v_accvgpr_read_b32 v202, a67
    s_nop 0
    v_mul_f32 v201, v201, v203
    v_mul_f32 v202, v202, v203
    v_accvgpr_write_b32 a66, v201
    v_accvgpr_write_b32 a67, v202
    v_accvgpr_read_b32 v201, a68
    v_accvgpr_read_b32 v202, a69
    s_nop 0
    v_mul_f32 v201, v201, v203
    v_mul_f32 v202, v202, v203
    v_accvgpr_write_b32 a68, v201
    v_accvgpr_write_b32 a69, v202
    v_accvgpr_read_b32 v201, a70
    v_accvgpr_read_b32 v202, a71
    s_nop 0
    v_mul_f32 v201, v201, v203
    v_mul_f32 v202, v202, v203
    v_accvgpr_write_b32 a70, v201
    v_accvgpr_write_b32 a71, v202
    v_accvgpr_read_b32 v201, a72
    v_accvgpr_read_b32 v202, a73
    s_nop 0
    v_mul_f32 v201, v201, v203
    v_mul_f32 v202, v202, v203
    v_accvgpr_write_b32 a72, v201
    v_accvgpr_write_b32 a73, v202
    v_accvgpr_read_b32 v201, a74
    v_accvgpr_read_b32 v202, a75
    s_nop 0
    v_mul_f32 v201, v201, v203
    v_mul_f32 v202, v202, v203
    v_accvgpr_write_b32 a74, v201
    v_accvgpr_write_b32 a75, v202
    v_accvgpr_read_b32 v201, a76
    v_accvgpr_read_b32 v202, a77
    s_nop 0
    v_mul_f32 v201, v201, v203
    v_mul_f32 v202, v202, v203
    v_accvgpr_write_b32 a76, v201
    v_accvgpr_write_b32 a77, v202
    v_accvgpr_read_b32 v201, a78
    v_accvgpr_read_b32 v202, a79
    s_nop 0
    v_mul_f32 v201, v201, v203
    v_mul_f32 v202, v202, v203
    v_accvgpr_write_b32 a78, v201
    v_accvgpr_write_b32 a79, v202
    v_accvgpr_read_b32 v201, a80
    v_accvgpr_read_b32 v202, a81
    s_nop 0
    v_mul_f32 v201, v201, v203
    v_mul_f32 v202, v202, v203
    v_accvgpr_write_b32 a80, v201
    v_accvgpr_write_b32 a81, v202
    v_accvgpr_read_b32 v201, a82
    v_accvgpr_read_b32 v202, a83
    s_nop 0
    v_mul_f32 v201, v201, v203
    v_mul_f32 v202, v202, v203
    v_accvgpr_write_b32 a82, v201
    v_accvgpr_write_b32 a83, v202
    v_accvgpr_read_b32 v201, a84
    v_accvgpr_read_b32 v202, a85
    s_nop 0
    v_mul_f32 v201, v201, v203
    v_mul_f32 v202, v202, v203
    v_accvgpr_write_b32 a84, v201
    v_accvgpr_write_b32 a85, v202
    v_accvgpr_read_b32 v201, a86
    v_accvgpr_read_b32 v202, a87
    s_nop 0
    v_mul_f32 v201, v201, v203
    v_mul_f32 v202, v202, v203
    v_accvgpr_write_b32 a86, v201
    v_accvgpr_write_b32 a87, v202
    v_accvgpr_read_b32 v201, a88
    v_accvgpr_read_b32 v202, a89
    s_nop 0
    v_mul_f32 v201, v201, v203
    v_mul_f32 v202, v202, v203
    v_accvgpr_write_b32 a88, v201
    v_accvgpr_write_b32 a89, v202
    v_accvgpr_read_b32 v201, a90
    v_accvgpr_read_b32 v202, a91
    s_nop 0
    v_mul_f32 v201, v201, v203
    v_mul_f32 v202, v202, v203
    v_accvgpr_write_b32 a90, v201
    v_accvgpr_write_b32 a91, v202
    v_accvgpr_read_b32 v201, a92
    v_accvgpr_read_b32 v202, a93
    s_nop 0
    v_mul_f32 v201, v201, v203
    v_mul_f32 v202, v202, v203
    v_accvgpr_write_b32 a92, v201
    v_accvgpr_write_b32 a93, v202
    v_accvgpr_read_b32 v201, a94
    v_accvgpr_read_b32 v202, a95
    s_nop 0
    v_mul_f32 v201, v201, v203
    v_mul_f32 v202, v202, v203
    v_accvgpr_write_b32 a94, v201
    v_accvgpr_write_b32 a95, v202
    v_accvgpr_read_b32 v201, a96
    v_accvgpr_read_b32 v202, a97
    s_nop 0
    v_mul_f32 v201, v201, v203
    v_mul_f32 v202, v202, v203
    v_accvgpr_write_b32 a96, v201
    v_accvgpr_write_b32 a97, v202
    v_accvgpr_read_b32 v201, a98
    v_accvgpr_read_b32 v202, a99
    s_nop 0
    v_mul_f32 v201, v201, v203
    v_mul_f32 v202, v202, v203
    v_accvgpr_write_b32 a98, v201
    v_accvgpr_write_b32 a99, v202
    v_accvgpr_read_b32 v201, a100
    v_accvgpr_read_b32 v202, a101
    s_nop 0
    v_mul_f32 v201, v201, v203
    v_mul_f32 v202, v202, v203
    v_accvgpr_write_b32 a100, v201
    v_accvgpr_write_b32 a101, v202
    v_accvgpr_read_b32 v201, a102
    v_accvgpr_read_b32 v202, a103
    s_nop 0
    v_mul_f32 v201, v201, v203
    v_mul_f32 v202, v202, v203
    v_accvgpr_write_b32 a102, v201
    v_accvgpr_write_b32 a103, v202
    v_accvgpr_read_b32 v201, a104
    v_accvgpr_read_b32 v202, a105
    s_nop 0
    v_mul_f32 v201, v201, v203
    v_mul_f32 v202, v202, v203
    v_accvgpr_write_b32 a104, v201
    v_accvgpr_write_b32 a105, v202
    v_accvgpr_read_b32 v201, a106
    v_accvgpr_read_b32 v202, a107
    s_nop 0
    v_mul_f32 v201, v201, v203
    v_mul_f32 v202, v202, v203
    v_accvgpr_write_b32 a106, v201
    v_accvgpr_write_b32 a107, v202
    v_accvgpr_read_b32 v201, a108
    v_accvgpr_read_b32 v202, a109
    s_nop 0
    v_mul_f32 v201, v201, v203
    v_mul_f32 v202, v202, v203
    v_accvgpr_write_b32 a108, v201
    v_accvgpr_write_b32 a109, v202
    v_accvgpr_read_b32 v201, a110
    v_accvgpr_read_b32 v202, a111
    s_nop 0
    v_mul_f32 v201, v201, v203
    v_mul_f32 v202, v202, v203
    v_accvgpr_write_b32 a110, v201
    v_accvgpr_write_b32 a111, v202
    v_accvgpr_read_b32 v201, a112
    v_accvgpr_read_b32 v202, a113
    s_nop 0
    v_mul_f32 v201, v201, v203
    v_mul_f32 v202, v202, v203
    v_accvgpr_write_b32 a112, v201
    v_accvgpr_write_b32 a113, v202
    v_accvgpr_read_b32 v201, a114
    v_accvgpr_read_b32 v202, a115
    s_nop 0
    v_mul_f32 v201, v201, v203
    v_mul_f32 v202, v202, v203
    v_accvgpr_write_b32 a114, v201
    v_accvgpr_write_b32 a115, v202
    v_accvgpr_read_b32 v201, a116
    v_accvgpr_read_b32 v202, a117
    s_nop 0
    v_mul_f32 v201, v201, v203
    v_mul_f32 v202, v202, v203
    v_accvgpr_write_b32 a116, v201
    v_accvgpr_write_b32 a117, v202
    v_accvgpr_read_b32 v201, a118
    v_accvgpr_read_b32 v202, a119
    s_nop 0
    v_mul_f32 v201, v201, v203
    v_mul_f32 v202, v202, v203
    v_accvgpr_write_b32 a118, v201
    v_accvgpr_write_b32 a119, v202
    v_accvgpr_read_b32 v201, a120
    v_accvgpr_read_b32 v202, a121
    s_nop 0
    v_mul_f32 v201, v201, v203
    v_mul_f32 v202, v202, v203
    v_accvgpr_write_b32 a120, v201
    v_accvgpr_write_b32 a121, v202
    v_accvgpr_read_b32 v201, a122
    v_accvgpr_read_b32 v202, a123
    s_nop 0
    v_mul_f32 v201, v201, v203
    v_mul_f32 v202, v202, v203
    v_accvgpr_write_b32 a122, v201
    v_accvgpr_write_b32 a123, v202
    v_accvgpr_read_b32 v201, a124
    v_accvgpr_read_b32 v202, a125
    s_nop 0
    v_mul_f32 v201, v201, v203
    v_mul_f32 v202, v202, v203
    v_accvgpr_write_b32 a124, v201
    v_accvgpr_write_b32 a125, v202
    v_accvgpr_read_b32 v201, a126
    v_accvgpr_read_b32 v202, a127
    s_nop 0
    v_mul_f32 v201, v201, v203
    v_mul_f32 v202, v202, v203
    v_accvgpr_write_b32 a126, v201
    v_accvgpr_write_b32 a127, v202
    s_nop 1
    s_branch RET_LA_1
RESC_LA_2:
    v_max_f32 v205, v12, v204
    v_sub_f32 v207, v12, v205
    v_exp_f32 v207, v207
    v_mov_b32 v12, v205
    s_nop 0
    v_mul_f32 v15, v15, v207
    s_cmp_eq_u32 s38, 0
    s_cbranch_scc1 RET_LA_2
    v_accvgpr_read_b32 v205, a128
    v_accvgpr_read_b32 v206, a129
    s_nop 0
    v_mul_f32 v205, v205, v207
    v_mul_f32 v206, v206, v207
    v_accvgpr_write_b32 a128, v205
    v_accvgpr_write_b32 a129, v206
    v_accvgpr_read_b32 v205, a130
    v_accvgpr_read_b32 v206, a131
    s_nop 0
    v_mul_f32 v205, v205, v207
    v_mul_f32 v206, v206, v207
    v_accvgpr_write_b32 a130, v205
    v_accvgpr_write_b32 a131, v206
    v_accvgpr_read_b32 v205, a132
    v_accvgpr_read_b32 v206, a133
    s_nop 0
    v_mul_f32 v205, v205, v207
    v_mul_f32 v206, v206, v207
    v_accvgpr_write_b32 a132, v205
    v_accvgpr_write_b32 a133, v206
    v_accvgpr_read_b32 v205, a134
    v_accvgpr_read_b32 v206, a135
    s_nop 0
    v_mul_f32 v205, v205, v207
    v_mul_f32 v206, v206, v207
    v_accvgpr_write_b32 a134, v205
    v_accvgpr_write_b32 a135, v206
    v_accvgpr_read_b32 v205, a136
    v_accvgpr_read_b32 v206, a137
    s_nop 0
    v_mul_f32 v205, v205, v207
    v_mul_f32 v206, v206, v207
    v_accvgpr_write_b32 a136, v205
    v_accvgpr_write_b32 a137, v206
    v_accvgpr_read_b32 v205, a138
    v_accvgpr_read_b32 v206, a139
    s_nop 0
    v_mul_f32 v205, v205, v207
    v_mul_f32 v206, v206, v207
    v_accvgpr_write_b32 a138, v205
    v_accvgpr_write_b32 a139, v206
    v_accvgpr_read_b32 v205, a140
    v_accvgpr_read_b32 v206, a141
    s_nop 0
    v_mul_f32 v205, v205, v207
    v_mul_f32 v206, v206, v207
    v_accvgpr_write_b32 a140, v205
    v_accvgpr_write_b32 a141, v206
    v_accvgpr_read_b32 v205, a142
    v_accvgpr_read_b32 v206, a143
    s_nop 0
    v_mul_f32 v205, v205, v207
    v_mul_f32 v206, v206, v207
    v_accvgpr_write_b32 a142, v205
    v_accvgpr_write_b32 a143, v206
    v_accvgpr_read_b32 v205, a144
    v_accvgpr_read_b32 v206, a145
    s_nop 0
    v_mul_f32 v205, v205, v207
    v_mul_f32 v206, v206, v207
    v_accvgpr_write_b32 a144, v205
    v_accvgpr_write_b32 a145, v206
    v_accvgpr_read_b32 v205, a146
    v_accvgpr_read_b32 v206, a147
    s_nop 0
    v_mul_f32 v205, v205, v207
    v_mul_f32 v206, v206, v207
    v_accvgpr_write_b32 a146, v205
    v_accvgpr_write_b32 a147, v206
    v_accvgpr_read_b32 v205, a148
    v_accvgpr_read_b32 v206, a149
    s_nop 0
    v_mul_f32 v205, v205, v207
    v_mul_f32 v206, v206, v207
    v_accvgpr_write_b32 a148, v205
    v_accvgpr_write_b32 a149, v206
    v_accvgpr_read_b32 v205, a150
    v_accvgpr_read_b32 v206, a151
    s_nop 0
    v_mul_f32 v205, v205, v207
    v_mul_f32 v206, v206, v207
    v_accvgpr_write_b32 a150, v205
    v_accvgpr_write_b32 a151, v206
    v_accvgpr_read_b32 v205, a152
    v_accvgpr_read_b32 v206, a153
    s_nop 0
    v_mul_f32 v205, v205, v207
    v_mul_f32 v206, v206, v207
    v_accvgpr_write_b32 a152, v205
    v_accvgpr_write_b32 a153, v206
    v_accvgpr_read_b32 v205, a154
    v_accvgpr_read_b32 v206, a155
    s_nop 0
    v_mul_f32 v205, v205, v207
    v_mul_f32 v206, v206, v207
    v_accvgpr_write_b32 a154, v205
    v_accvgpr_write_b32 a155, v206
    v_accvgpr_read_b32 v205, a156
    v_accvgpr_read_b32 v206, a157
    s_nop 0
    v_mul_f32 v205, v205, v207
    v_mul_f32 v206, v206, v207
    v_accvgpr_write_b32 a156, v205
    v_accvgpr_write_b32 a157, v206
    v_accvgpr_read_b32 v205, a158
    v_accvgpr_read_b32 v206, a159
    s_nop 0
    v_mul_f32 v205, v205, v207
    v_mul_f32 v206, v206, v207
    v_accvgpr_write_b32 a158, v205
    v_accvgpr_write_b32 a159, v206
    v_accvgpr_read_b32 v205, a160
    v_accvgpr_read_b32 v206, a161
    s_nop 0
    v_mul_f32 v205, v205, v207
    v_mul_f32 v206, v206, v207
    v_accvgpr_write_b32 a160, v205
    v_accvgpr_write_b32 a161, v206
    v_accvgpr_read_b32 v205, a162
    v_accvgpr_read_b32 v206, a163
    s_nop 0
    v_mul_f32 v205, v205, v207
    v_mul_f32 v206, v206, v207
    v_accvgpr_write_b32 a162, v205
    v_accvgpr_write_b32 a163, v206
    v_accvgpr_read_b32 v205, a164
    v_accvgpr_read_b32 v206, a165
    s_nop 0
    v_mul_f32 v205, v205, v207
    v_mul_f32 v206, v206, v207
    v_accvgpr_write_b32 a164, v205
    v_accvgpr_write_b32 a165, v206
    v_accvgpr_read_b32 v205, a166
    v_accvgpr_read_b32 v206, a167
    s_nop 0
    v_mul_f32 v205, v205, v207
    v_mul_f32 v206, v206, v207
    v_accvgpr_write_b32 a166, v205
    v_accvgpr_write_b32 a167, v206
    v_accvgpr_read_b32 v205, a168
    v_accvgpr_read_b32 v206, a169
    s_nop 0
    v_mul_f32 v205, v205, v207
    v_mul_f32 v206, v206, v207
    v_accvgpr_write_b32 a168, v205
    v_accvgpr_write_b32 a169, v206
    v_accvgpr_read_b32 v205, a170
    v_accvgpr_read_b32 v206, a171
    s_nop 0
    v_mul_f32 v205, v205, v207
    v_mul_f32 v206, v206, v207
    v_accvgpr_write_b32 a170, v205
    v_accvgpr_write_b32 a171, v206
    v_accvgpr_read_b32 v205, a172
    v_accvgpr_read_b32 v206, a173
    s_nop 0
    v_mul_f32 v205, v205, v207
    v_mul_f32 v206, v206, v207
    v_accvgpr_write_b32 a172, v205
    v_accvgpr_write_b32 a173, v206
    v_accvgpr_read_b32 v205, a174
    v_accvgpr_read_b32 v206, a175
    s_nop 0
    v_mul_f32 v205, v205, v207
    v_mul_f32 v206, v206, v207
    v_accvgpr_write_b32 a174, v205
    v_accvgpr_write_b32 a175, v206
    v_accvgpr_read_b32 v205, a176
    v_accvgpr_read_b32 v206, a177
    s_nop 0
    v_mul_f32 v205, v205, v207
    v_mul_f32 v206, v206, v207
    v_accvgpr_write_b32 a176, v205
    v_accvgpr_write_b32 a177, v206
    v_accvgpr_read_b32 v205, a178
    v_accvgpr_read_b32 v206, a179
    s_nop 0
    v_mul_f32 v205, v205, v207
    v_mul_f32 v206, v206, v207
    v_accvgpr_write_b32 a178, v205
    v_accvgpr_write_b32 a179, v206
    v_accvgpr_read_b32 v205, a180
    v_accvgpr_read_b32 v206, a181
    s_nop 0
    v_mul_f32 v205, v205, v207
    v_mul_f32 v206, v206, v207
    v_accvgpr_write_b32 a180, v205
    v_accvgpr_write_b32 a181, v206
    v_accvgpr_read_b32 v205, a182
    v_accvgpr_read_b32 v206, a183
    s_nop 0
    v_mul_f32 v205, v205, v207
    v_mul_f32 v206, v206, v207
    v_accvgpr_write_b32 a182, v205
    v_accvgpr_write_b32 a183, v206
    v_accvgpr_read_b32 v205, a184
    v_accvgpr_read_b32 v206, a185
    s_nop 0
    v_mul_f32 v205, v205, v207
    v_mul_f32 v206, v206, v207
    v_accvgpr_write_b32 a184, v205
    v_accvgpr_write_b32 a185, v206
    v_accvgpr_read_b32 v205, a186
    v_accvgpr_read_b32 v206, a187
    s_nop 0
    v_mul_f32 v205, v205, v207
    v_mul_f32 v206, v206, v207
    v_accvgpr_write_b32 a186, v205
    v_accvgpr_write_b32 a187, v206
    v_accvgpr_read_b32 v205, a188
    v_accvgpr_read_b32 v206, a189
    s_nop 0
    v_mul_f32 v205, v205, v207
    v_mul_f32 v206, v206, v207
    v_accvgpr_write_b32 a188, v205
    v_accvgpr_write_b32 a189, v206
    v_accvgpr_read_b32 v205, a190
    v_accvgpr_read_b32 v206, a191
    s_nop 0
    v_mul_f32 v205, v205, v207
    v_mul_f32 v206, v206, v207
    v_accvgpr_write_b32 a190, v205
    v_accvgpr_write_b32 a191, v206
    s_nop 1
    s_branch RET_LA_2
RESC_LB_0:
    v_max_f32 v197, v10, v196
    v_sub_f32 v199, v10, v197
    v_exp_f32 v199, v199
    v_mov_b32 v10, v197
    s_nop 0
    v_mul_f32 v13, v13, v199
    s_cmp_eq_u32 s38, 0
    s_cbranch_scc1 RET_LB_0
    v_accvgpr_read_b32 v197, a0
    v_accvgpr_read_b32 v198, a1
    s_nop 0
    v_mul_f32 v197, v197, v199
    v_mul_f32 v198, v198, v199
    v_accvgpr_write_b32 a0, v197
    v_accvgpr_write_b32 a1, v198
    v_accvgpr_read_b32 v197, a2
    v_accvgpr_read_b32 v198, a3
    s_nop 0
    v_mul_f32 v197, v197, v199
    v_mul_f32 v198, v198, v199
    v_accvgpr_write_b32 a2, v197
    v_accvgpr_write_b32 a3, v198
    v_accvgpr_read_b32 v197, a4
    v_accvgpr_read_b32 v198, a5
    s_nop 0
    v_mul_f32 v197, v197, v199
    v_mul_f32 v198, v198, v199
    v_accvgpr_write_b32 a4, v197
    v_accvgpr_write_b32 a5, v198
    v_accvgpr_read_b32 v197, a6
    v_accvgpr_read_b32 v198, a7
    s_nop 0
    v_mul_f32 v197, v197, v199
    v_mul_f32 v198, v198, v199
    v_accvgpr_write_b32 a6, v197
    v_accvgpr_write_b32 a7, v198
    v_accvgpr_read_b32 v197, a8
    v_accvgpr_read_b32 v198, a9
    s_nop 0
    v_mul_f32 v197, v197, v199
    v_mul_f32 v198, v198, v199
    v_accvgpr_write_b32 a8, v197
    v_accvgpr_write_b32 a9, v198
    v_accvgpr_read_b32 v197, a10
    v_accvgpr_read_b32 v198, a11
    s_nop 0
    v_mul_f32 v197, v197, v199
    v_mul_f32 v198, v198, v199
    v_accvgpr_write_b32 a10, v197
    v_accvgpr_write_b32 a11, v198
    v_accvgpr_read_b32 v197, a12
    v_accvgpr_read_b32 v198, a13
    s_nop 0
    v_mul_f32 v197, v197, v199
    v_mul_f32 v198, v198, v199
    v_accvgpr_write_b32 a12, v197
    v_accvgpr_write_b32 a13, v198
    v_accvgpr_read_b32 v197, a14
    v_accvgpr_read_b32 v198, a15
    s_nop 0
    v_mul_f32 v197, v197, v199
    v_mul_f32 v198, v198, v199
    v_accvgpr_write_b32 a14, v197
    v_accvgpr_write_b32 a15, v198
    v_accvgpr_read_b32 v197, a16
    v_accvgpr_read_b32 v198, a17
    s_nop 0
    v_mul_f32 v197, v197, v199
    v_mul_f32 v198, v198, v199
    v_accvgpr_write_b32 a16, v197
    v_accvgpr_write_b32 a17, v198
    v_accvgpr_read_b32 v197, a18
    v_accvgpr_read_b32 v198, a19
    s_nop 0
    v_mul_f32 v197, v197, v199
    v_mul_f32 v198, v198, v199
    v_accvgpr_write_b32 a18, v197
    v_accvgpr_write_b32 a19, v198
    v_accvgpr_read_b32 v197, a20
    v_accvgpr_read_b32 v198, a21
    s_nop 0
    v_mul_f32 v197, v197, v199
    v_mul_f32 v198, v198, v199
    v_accvgpr_write_b32 a20, v197
    v_accvgpr_write_b32 a21, v198
    v_accvgpr_read_b32 v197, a22
    v_accvgpr_read_b32 v198, a23
    s_nop 0
    v_mul_f32 v197, v197, v199
    v_mul_f32 v198, v198, v199
    v_accvgpr_write_b32 a22, v197
    v_accvgpr_write_b32 a23, v198
    v_accvgpr_read_b32 v197, a24
    v_accvgpr_read_b32 v198, a25
    s_nop 0
    v_mul_f32 v197, v197, v199
    v_mul_f32 v198, v198, v199
    v_accvgpr_write_b32 a24, v197
    v_accvgpr_write_b32 a25, v198
    v_accvgpr_read_b32 v197, a26
    v_accvgpr_read_b32 v198, a27
    s_nop 0
    v_mul_f32 v197, v197, v199
    v_mul_f32 v198, v198, v199
    v_accvgpr_write_b32 a26, v197
    v_accvgpr_write_b32 a27, v198
    v_accvgpr_read_b32 v197, a28
    v_accvgpr_read_b32 v198, a29
    s_nop 0
    v_mul_f32 v197, v197, v199
    v_mul_f32 v198, v198, v199
    v_accvgpr_write_b32 a28, v197
    v_accvgpr_write_b32 a29, v198
    v_accvgpr_read_b32 v197, a30
    v_accvgpr_read_b32 v198, a31
    s_nop 0
    v_mul_f32 v197, v197, v199
    v_mul_f32 v198, v198, v199
    v_accvgpr_write_b32 a30, v197
    v_accvgpr_write_b32 a31, v198
    v_accvgpr_read_b32 v197, a32
    v_accvgpr_read_b32 v198, a33
    s_nop 0
    v_mul_f32 v197, v197, v199
    v_mul_f32 v198, v198, v199
    v_accvgpr_write_b32 a32, v197
    v_accvgpr_write_b32 a33, v198
    v_accvgpr_read_b32 v197, a34
    v_accvgpr_read_b32 v198, a35
    s_nop 0
    v_mul_f32 v197, v197, v199
    v_mul_f32 v198, v198, v199
    v_accvgpr_write_b32 a34, v197
    v_accvgpr_write_b32 a35, v198
    v_accvgpr_read_b32 v197, a36
    v_accvgpr_read_b32 v198, a37
    s_nop 0
    v_mul_f32 v197, v197, v199
    v_mul_f32 v198, v198, v199
    v_accvgpr_write_b32 a36, v197
    v_accvgpr_write_b32 a37, v198
    v_accvgpr_read_b32 v197, a38
    v_accvgpr_read_b32 v198, a39
    s_nop 0
    v_mul_f32 v197, v197, v199
    v_mul_f32 v198, v198, v199
    v_accvgpr_write_b32 a38, v197
    v_accvgpr_write_b32 a39, v198
    v_accvgpr_read_b32 v197, a40
    v_accvgpr_read_b32 v198, a41
    s_nop 0
    v_mul_f32 v197, v197, v199
    v_mul_f32 v198, v198, v199
    v_accvgpr_write_b32 a40, v197
    v_accvgpr_write_b32 a41, v198
    v_accvgpr_read_b32 v197, a42
    v_accvgpr_read_b32 v198, a43
    s_nop 0
    v_mul_f32 v197, v197, v199
    v_mul_f32 v198, v198, v199
    v_accvgpr_write_b32 a42, v197
    v_accvgpr_write_b32 a43, v198
    v_accvgpr_read_b32 v197, a44
    v_accvgpr_read_b32 v198, a45
    s_nop 0
    v_mul_f32 v197, v197, v199
    v_mul_f32 v198, v198, v199
    v_accvgpr_write_b32 a44, v197
    v_accvgpr_write_b32 a45, v198
    v_accvgpr_read_b32 v197, a46
    v_accvgpr_read_b32 v198, a47
    s_nop 0
    v_mul_f32 v197, v197, v199
    v_mul_f32 v198, v198, v199
    v_accvgpr_write_b32 a46, v197
    v_accvgpr_write_b32 a47, v198
    v_accvgpr_read_b32 v197, a48
    v_accvgpr_read_b32 v198, a49
    s_nop 0
    v_mul_f32 v197, v197, v199
    v_mul_f32 v198, v198, v199
    v_accvgpr_write_b32 a48, v197
    v_accvgpr_write_b32 a49, v198
    v_accvgpr_read_b32 v197, a50
    v_accvgpr_read_b32 v198, a51
    s_nop 0
    v_mul_f32 v197, v197, v199
    v_mul_f32 v198, v198, v199
    v_accvgpr_write_b32 a50, v197
    v_accvgpr_write_b32 a51, v198
    v_accvgpr_read_b32 v197, a52
    v_accvgpr_read_b32 v198, a53
    s_nop 0
    v_mul_f32 v197, v197, v199
    v_mul_f32 v198, v198, v199
    v_accvgpr_write_b32 a52, v197
    v_accvgpr_write_b32 a53, v198
    v_accvgpr_read_b32 v197, a54
    v_accvgpr_read_b32 v198, a55
    s_nop 0
    v_mul_f32 v197, v197, v199
    v_mul_f32 v198, v198, v199
    v_accvgpr_write_b32 a54, v197
    v_accvgpr_write_b32 a55, v198
    v_accvgpr_read_b32 v197, a56
    v_accvgpr_read_b32 v198, a57
    s_nop 0
    v_mul_f32 v197, v197, v199
    v_mul_f32 v198, v198, v199
    v_accvgpr_write_b32 a56, v197
    v_accvgpr_write_b32 a57, v198
    v_accvgpr_read_b32 v197, a58
    v_accvgpr_read_b32 v198, a59
    s_nop 0
    v_mul_f32 v197, v197, v199
    v_mul_f32 v198, v198, v199
    v_accvgpr_write_b32 a58, v197
    v_accvgpr_write_b32 a59, v198
    v_accvgpr_read_b32 v197, a60
    v_accvgpr_read_b32 v198, a61
    s_nop 0
    v_mul_f32 v197, v197, v199
    v_mul_f32 v198, v198, v199
    v_accvgpr_write_b32 a60, v197
    v_accvgpr_write_b32 a61, v198
    v_accvgpr_read_b32 v197, a62
    v_accvgpr_read_b32 v198, a63
    s_nop 0
    v_mul_f32 v197, v197, v199
    v_mul_f32 v198, v198, v199
    v_accvgpr_write_b32 a62, v197
    v_accvgpr_write_b32 a63, v198
    s_nop 1
    s_branch RET_LB_0
RESC_LB_1:
    v_max_f32 v201, v11, v200
    v_sub_f32 v203, v11, v201
    v_exp_f32 v203, v203
    v_mov_b32 v11, v201
    s_nop 0
    v_mul_f32 v14, v14, v203
    s_cmp_eq_u32 s38, 0
    s_cbranch_scc1 RET_LB_1
    v_accvgpr_read_b32 v201, a64
    v_accvgpr_read_b32 v202, a65
    s_nop 0
    v_mul_f32 v201, v201, v203
    v_mul_f32 v202, v202, v203
    v_accvgpr_write_b32 a64, v201
    v_accvgpr_write_b32 a65, v202
    v_accvgpr_read_b32 v201, a66
    v_accvgpr_read_b32 v202, a67
    s_nop 0
    v_mul_f32 v201, v201, v203
    v_mul_f32 v202, v202, v203
    v_accvgpr_write_b32 a66, v201
    v_accvgpr_write_b32 a67, v202
    v_accvgpr_read_b32 v201, a68
    v_accvgpr_read_b32 v202, a69
    s_nop 0
    v_mul_f32 v201, v201, v203
    v_mul_f32 v202, v202, v203
    v_accvgpr_write_b32 a68, v201
    v_accvgpr_write_b32 a69, v202
    v_accvgpr_read_b32 v201, a70
    v_accvgpr_read_b32 v202, a71
    s_nop 0
    v_mul_f32 v201, v201, v203
    v_mul_f32 v202, v202, v203
    v_accvgpr_write_b32 a70, v201
    v_accvgpr_write_b32 a71, v202
    v_accvgpr_read_b32 v201, a72
    v_accvgpr_read_b32 v202, a73
    s_nop 0
    v_mul_f32 v201, v201, v203
    v_mul_f32 v202, v202, v203
    v_accvgpr_write_b32 a72, v201
    v_accvgpr_write_b32 a73, v202
    v_accvgpr_read_b32 v201, a74
    v_accvgpr_read_b32 v202, a75
    s_nop 0
    v_mul_f32 v201, v201, v203
    v_mul_f32 v202, v202, v203
    v_accvgpr_write_b32 a74, v201
    v_accvgpr_write_b32 a75, v202
    v_accvgpr_read_b32 v201, a76
    v_accvgpr_read_b32 v202, a77
    s_nop 0
    v_mul_f32 v201, v201, v203
    v_mul_f32 v202, v202, v203
    v_accvgpr_write_b32 a76, v201
    v_accvgpr_write_b32 a77, v202
    v_accvgpr_read_b32 v201, a78
    v_accvgpr_read_b32 v202, a79
    s_nop 0
    v_mul_f32 v201, v201, v203
    v_mul_f32 v202, v202, v203
    v_accvgpr_write_b32 a78, v201
    v_accvgpr_write_b32 a79, v202
    v_accvgpr_read_b32 v201, a80
    v_accvgpr_read_b32 v202, a81
    s_nop 0
    v_mul_f32 v201, v201, v203
    v_mul_f32 v202, v202, v203
    v_accvgpr_write_b32 a80, v201
    v_accvgpr_write_b32 a81, v202
    v_accvgpr_read_b32 v201, a82
    v_accvgpr_read_b32 v202, a83
    s_nop 0
    v_mul_f32 v201, v201, v203
    v_mul_f32 v202, v202, v203
    v_accvgpr_write_b32 a82, v201
    v_accvgpr_write_b32 a83, v202
    v_accvgpr_read_b32 v201, a84
    v_accvgpr_read_b32 v202, a85
    s_nop 0
    v_mul_f32 v201, v201, v203
    v_mul_f32 v202, v202, v203
    v_accvgpr_write_b32 a84, v201
    v_accvgpr_write_b32 a85, v202
    v_accvgpr_read_b32 v201, a86
    v_accvgpr_read_b32 v202, a87
    s_nop 0
    v_mul_f32 v201, v201, v203
    v_mul_f32 v202, v202, v203
    v_accvgpr_write_b32 a86, v201
    v_accvgpr_write_b32 a87, v202
    v_accvgpr_read_b32 v201, a88
    v_accvgpr_read_b32 v202, a89
    s_nop 0
    v_mul_f32 v201, v201, v203
    v_mul_f32 v202, v202, v203
    v_accvgpr_write_b32 a88, v201
    v_accvgpr_write_b32 a89, v202
    v_accvgpr_read_b32 v201, a90
    v_accvgpr_read_b32 v202, a91
    s_nop 0
    v_mul_f32 v201, v201, v203
    v_mul_f32 v202, v202, v203
    v_accvgpr_write_b32 a90, v201
    v_accvgpr_write_b32 a91, v202
    v_accvgpr_read_b32 v201, a92
    v_accvgpr_read_b32 v202, a93
    s_nop 0
    v_mul_f32 v201, v201, v203
    v_mul_f32 v202, v202, v203
    v_accvgpr_write_b32 a92, v201
    v_accvgpr_write_b32 a93, v202
    v_accvgpr_read_b32 v201, a94
    v_accvgpr_read_b32 v202, a95
    s_nop 0
    v_mul_f32 v201, v201, v203
    v_mul_f32 v202, v202, v203
    v_accvgpr_write_b32 a94, v201
    v_accvgpr_write_b32 a95, v202
    v_accvgpr_read_b32 v201, a96
    v_accvgpr_read_b32 v202, a97
    s_nop 0
    v_mul_f32 v201, v201, v203
    v_mul_f32 v202, v202, v203
    v_accvgpr_write_b32 a96, v201
    v_accvgpr_write_b32 a97, v202
    v_accvgpr_read_b32 v201, a98
    v_accvgpr_read_b32 v202, a99
    s_nop 0
    v_mul_f32 v201, v201, v203
    v_mul_f32 v202, v202, v203
    v_accvgpr_write_b32 a98, v201
    v_accvgpr_write_b32 a99, v202
    v_accvgpr_read_b32 v201, a100
    v_accvgpr_read_b32 v202, a101
    s_nop 0
    v_mul_f32 v201, v201, v203
    v_mul_f32 v202, v202, v203
    v_accvgpr_write_b32 a100, v201
    v_accvgpr_write_b32 a101, v202
    v_accvgpr_read_b32 v201, a102
    v_accvgpr_read_b32 v202, a103
    s_nop 0
    v_mul_f32 v201, v201, v203
    v_mul_f32 v202, v202, v203
    v_accvgpr_write_b32 a102, v201
    v_accvgpr_write_b32 a103, v202
    v_accvgpr_read_b32 v201, a104
    v_accvgpr_read_b32 v202, a105
    s_nop 0
    v_mul_f32 v201, v201, v203
    v_mul_f32 v202, v202, v203
    v_accvgpr_write_b32 a104, v201
    v_accvgpr_write_b32 a105, v202
    v_accvgpr_read_b32 v201, a106
    v_accvgpr_read_b32 v202, a107
    s_nop 0
    v_mul_f32 v201, v201, v203
    v_mul_f32 v202, v202, v203
    v_accvgpr_write_b32 a106, v201
    v_accvgpr_write_b32 a107, v202
    v_accvgpr_read_b32 v201, a108
    v_accvgpr_read_b32 v202, a109
    s_nop 0
    v_mul_f32 v201, v201, v203
    v_mul_f32 v202, v202, v203
    v_accvgpr_write_b32 a108, v201
    v_accvgpr_write_b32 a109, v202
    v_accvgpr_read_b32 v201, a110
    v_accvgpr_read_b32 v202, a111
    s_nop 0
    v_mul_f32 v201, v201, v203
    v_mul_f32 v202, v202, v203
    v_accvgpr_write_b32 a110, v201
    v_accvgpr_write_b32 a111, v202
    v_accvgpr_read_b32 v201, a112
    v_accvgpr_read_b32 v202, a113
    s_nop 0
    v_mul_f32 v201, v201, v203
    v_mul_f32 v202, v202, v203
    v_accvgpr_write_b32 a112, v201
    v_accvgpr_write_b32 a113, v202
    v_accvgpr_read_b32 v201, a114
    v_accvgpr_read_b32 v202, a115
    s_nop 0
    v_mul_f32 v201, v201, v203
    v_mul_f32 v202, v202, v203
    v_accvgpr_write_b32 a114, v201
    v_accvgpr_write_b32 a115, v202
    v_accvgpr_read_b32 v201, a116
    v_accvgpr_read_b32 v202, a117
    s_nop 0
    v_mul_f32 v201, v201, v203
    v_mul_f32 v202, v202, v203
    v_accvgpr_write_b32 a116, v201
    v_accvgpr_write_b32 a117, v202
    v_accvgpr_read_b32 v201, a118
    v_accvgpr_read_b32 v202, a119
    s_nop 0
    v_mul_f32 v201, v201, v203
    v_mul_f32 v202, v202, v203
    v_accvgpr_write_b32 a118, v201
    v_accvgpr_write_b32 a119, v202
    v_accvgpr_read_b32 v201, a120
    v_accvgpr_read_b32 v202, a121
    s_nop 0
    v_mul_f32 v201, v201, v203
    v_mul_f32 v202, v202, v203
    v_accvgpr_write_b32 a120, v201
    v_accvgpr_write_b32 a121, v202
    v_accvgpr_read_b32 v201, a122
    v_accvgpr_read_b32 v202, a123
    s_nop 0
    v_mul_f32 v201, v201, v203
    v_mul_f32 v202, v202, v203
    v_accvgpr_write_b32 a122, v201
    v_accvgpr_write_b32 a123, v202
    v_accvgpr_read_b32 v201, a124
    v_accvgpr_read_b32 v202, a125
    s_nop 0
    v_mul_f32 v201, v201, v203
    v_mul_f32 v202, v202, v203
    v_accvgpr_write_b32 a124, v201
    v_accvgpr_write_b32 a125, v202
    v_accvgpr_read_b32 v201, a126
    v_accvgpr_read_b32 v202, a127
    s_nop 0
    v_mul_f32 v201, v201, v203
    v_mul_f32 v202, v202, v203
    v_accvgpr_write_b32 a126, v201
    v_accvgpr_write_b32 a127, v202
    s_nop 1
    s_branch RET_LB_1
RESC_LB_2:
    v_max_f32 v205, v12, v204
    v_sub_f32 v207, v12, v205
    v_exp_f32 v207, v207
    v_mov_b32 v12, v205
    s_nop 0
    v_mul_f32 v15, v15, v207
    s_cmp_eq_u32 s38, 0
    s_cbranch_scc1 RET_LB_2
    v_accvgpr_read_b32 v205, a128
    v_accvgpr_read_b32 v206, a129
    s_nop 0
    v_mul_f32 v205, v205, v207
    v_mul_f32 v206, v206, v207
    v_accvgpr_write_b32 a128, v205
    v_accvgpr_write_b32 a129, v206
    v_accvgpr_read_b32 v205, a130
    v_accvgpr_read_b32 v206, a131
    s_nop 0
    v_mul_f32 v205, v205, v207
    v_mul_f32 v206, v206, v207
    v_accvgpr_write_b32 a130, v205
    v_accvgpr_write_b32 a131, v206
    v_accvgpr_read_b32 v205, a132
    v_accvgpr_read_b32 v206, a133
    s_nop 0
    v_mul_f32 v205, v205, v207
    v_mul_f32 v206, v206, v207
    v_accvgpr_write_b32 a132, v205
    v_accvgpr_write_b32 a133, v206
    v_accvgpr_read_b32 v205, a134
    v_accvgpr_read_b32 v206, a135
    s_nop 0
    v_mul_f32 v205, v205, v207
    v_mul_f32 v206, v206, v207
    v_accvgpr_write_b32 a134, v205
    v_accvgpr_write_b32 a135, v206
    v_accvgpr_read_b32 v205, a136
    v_accvgpr_read_b32 v206, a137
    s_nop 0
    v_mul_f32 v205, v205, v207
    v_mul_f32 v206, v206, v207
    v_accvgpr_write_b32 a136, v205
    v_accvgpr_write_b32 a137, v206
    v_accvgpr_read_b32 v205, a138
    v_accvgpr_read_b32 v206, a139
    s_nop 0
    v_mul_f32 v205, v205, v207
    v_mul_f32 v206, v206, v207
    v_accvgpr_write_b32 a138, v205
    v_accvgpr_write_b32 a139, v206
    v_accvgpr_read_b32 v205, a140
    v_accvgpr_read_b32 v206, a141
    s_nop 0
    v_mul_f32 v205, v205, v207
    v_mul_f32 v206, v206, v207
    v_accvgpr_write_b32 a140, v205
    v_accvgpr_write_b32 a141, v206
    v_accvgpr_read_b32 v205, a142
    v_accvgpr_read_b32 v206, a143
    s_nop 0
    v_mul_f32 v205, v205, v207
    v_mul_f32 v206, v206, v207
    v_accvgpr_write_b32 a142, v205
    v_accvgpr_write_b32 a143, v206
    v_accvgpr_read_b32 v205, a144
    v_accvgpr_read_b32 v206, a145
    s_nop 0
    v_mul_f32 v205, v205, v207
    v_mul_f32 v206, v206, v207
    v_accvgpr_write_b32 a144, v205
    v_accvgpr_write_b32 a145, v206
    v_accvgpr_read_b32 v205, a146
    v_accvgpr_read_b32 v206, a147
    s_nop 0
    v_mul_f32 v205, v205, v207
    v_mul_f32 v206, v206, v207
    v_accvgpr_write_b32 a146, v205
    v_accvgpr_write_b32 a147, v206
    v_accvgpr_read_b32 v205, a148
    v_accvgpr_read_b32 v206, a149
    s_nop 0
    v_mul_f32 v205, v205, v207
    v_mul_f32 v206, v206, v207
    v_accvgpr_write_b32 a148, v205
    v_accvgpr_write_b32 a149, v206
    v_accvgpr_read_b32 v205, a150
    v_accvgpr_read_b32 v206, a151
    s_nop 0
    v_mul_f32 v205, v205, v207
    v_mul_f32 v206, v206, v207
    v_accvgpr_write_b32 a150, v205
    v_accvgpr_write_b32 a151, v206
    v_accvgpr_read_b32 v205, a152
    v_accvgpr_read_b32 v206, a153
    s_nop 0
    v_mul_f32 v205, v205, v207
    v_mul_f32 v206, v206, v207
    v_accvgpr_write_b32 a152, v205
    v_accvgpr_write_b32 a153, v206
    v_accvgpr_read_b32 v205, a154
    v_accvgpr_read_b32 v206, a155
    s_nop 0
    v_mul_f32 v205, v205, v207
    v_mul_f32 v206, v206, v207
    v_accvgpr_write_b32 a154, v205
    v_accvgpr_write_b32 a155, v206
    v_accvgpr_read_b32 v205, a156
    v_accvgpr_read_b32 v206, a157
    s_nop 0
    v_mul_f32 v205, v205, v207
    v_mul_f32 v206, v206, v207
    v_accvgpr_write_b32 a156, v205
    v_accvgpr_write_b32 a157, v206
    v_accvgpr_read_b32 v205, a158
    v_accvgpr_read_b32 v206, a159
    s_nop 0
    v_mul_f32 v205, v205, v207
    v_mul_f32 v206, v206, v207
    v_accvgpr_write_b32 a158, v205
    v_accvgpr_write_b32 a159, v206
    v_accvgpr_read_b32 v205, a160
    v_accvgpr_read_b32 v206, a161
    s_nop 0
    v_mul_f32 v205, v205, v207
    v_mul_f32 v206, v206, v207
    v_accvgpr_write_b32 a160, v205
    v_accvgpr_write_b32 a161, v206
    v_accvgpr_read_b32 v205, a162
    v_accvgpr_read_b32 v206, a163
    s_nop 0
    v_mul_f32 v205, v205, v207
    v_mul_f32 v206, v206, v207
    v_accvgpr_write_b32 a162, v205
    v_accvgpr_write_b32 a163, v206
    v_accvgpr_read_b32 v205, a164
    v_accvgpr_read_b32 v206, a165
    s_nop 0
    v_mul_f32 v205, v205, v207
    v_mul_f32 v206, v206, v207
    v_accvgpr_write_b32 a164, v205
    v_accvgpr_write_b32 a165, v206
    v_accvgpr_read_b32 v205, a166
    v_accvgpr_read_b32 v206, a167
    s_nop 0
    v_mul_f32 v205, v205, v207
    v_mul_f32 v206, v206, v207
    v_accvgpr_write_b32 a166, v205
    v_accvgpr_write_b32 a167, v206
    v_accvgpr_read_b32 v205, a168
    v_accvgpr_read_b32 v206, a169
    s_nop 0
    v_mul_f32 v205, v205, v207
    v_mul_f32 v206, v206, v207
    v_accvgpr_write_b32 a168, v205
    v_accvgpr_write_b32 a169, v206
    v_accvgpr_read_b32 v205, a170
    v_accvgpr_read_b32 v206, a171
    s_nop 0
    v_mul_f32 v205, v205, v207
    v_mul_f32 v206, v206, v207
    v_accvgpr_write_b32 a170, v205
    v_accvgpr_write_b32 a171, v206
    v_accvgpr_read_b32 v205, a172
    v_accvgpr_read_b32 v206, a173
    s_nop 0
    v_mul_f32 v205, v205, v207
    v_mul_f32 v206, v206, v207
    v_accvgpr_write_b32 a172, v205
    v_accvgpr_write_b32 a173, v206
    v_accvgpr_read_b32 v205, a174
    v_accvgpr_read_b32 v206, a175
    s_nop 0
    v_mul_f32 v205, v205, v207
    v_mul_f32 v206, v206, v207
    v_accvgpr_write_b32 a174, v205
    v_accvgpr_write_b32 a175, v206
    v_accvgpr_read_b32 v205, a176
    v_accvgpr_read_b32 v206, a177
    s_nop 0
    v_mul_f32 v205, v205, v207
    v_mul_f32 v206, v206, v207
    v_accvgpr_write_b32 a176, v205
    v_accvgpr_write_b32 a177, v206
    v_accvgpr_read_b32 v205, a178
    v_accvgpr_read_b32 v206, a179
    s_nop 0
    v_mul_f32 v205, v205, v207
    v_mul_f32 v206, v206, v207
    v_accvgpr_write_b32 a178, v205
    v_accvgpr_write_b32 a179, v206
    v_accvgpr_read_b32 v205, a180
    v_accvgpr_read_b32 v206, a181
    s_nop 0
    v_mul_f32 v205, v205, v207
    v_mul_f32 v206, v206, v207
    v_accvgpr_write_b32 a180, v205
    v_accvgpr_write_b32 a181, v206
    v_accvgpr_read_b32 v205, a182
    v_accvgpr_read_b32 v206, a183
    s_nop 0
    v_mul_f32 v205, v205, v207
    v_mul_f32 v206, v206, v207
    v_accvgpr_write_b32 a182, v205
    v_accvgpr_write_b32 a183, v206
    v_accvgpr_read_b32 v205, a184
    v_accvgpr_read_b32 v206, a185
    s_nop 0
    v_mul_f32 v205, v205, v207
    v_mul_f32 v206, v206, v207
    v_accvgpr_write_b32 a184, v205
    v_accvgpr_write_b32 a185, v206
    v_accvgpr_read_b32 v205, a186
    v_accvgpr_read_b32 v206, a187
    s_nop 0
    v_mul_f32 v205, v205, v207
    v_mul_f32 v206, v206, v207
    v_accvgpr_write_b32 a186, v205
    v_accvgpr_write_b32 a187, v206
    v_accvgpr_read_b32 v205, a188
    v_accvgpr_read_b32 v206, a189
    s_nop 0
    v_mul_f32 v205, v205, v207
    v_mul_f32 v206, v206, v207
    v_accvgpr_write_b32 a188, v205
    v_accvgpr_write_b32 a189, v206
    v_accvgpr_read_b32 v205, a190
    v_accvgpr_read_b32 v206, a191
    s_nop 0
    v_mul_f32 v205, v205, v207
    v_mul_f32 v206, v206, v207
    v_accvgpr_write_b32 a190, v205
    v_accvgpr_write_b32 a191, v206
    s_nop 1
    s_branch RET_LB_2
.section .rodata,"a"
.p2align 6
.amdhsa_kernel standalone__gqa_softmax__near_ridge_kernel
  .amdhsa_next_free_vgpr 512
  .amdhsa_next_free_sgpr 102
  .amdhsa_accum_offset 256
  .amdhsa_group_segment_fixed_size 0
  .amdhsa_kernarg_size 48
  .amdhsa_user_sgpr_count 2
  .amdhsa_user_sgpr_kernarg_segment_ptr 1
  .amdhsa_system_sgpr_workgroup_id_x 1
.end_amdhsa_kernel
```
